```python
import torch

def _softmax(x, axis=-1):
    return torch.softmax(x, dim=axis)

def _gelu(x):
    return torch.nn.functional.gelu(x, approximate='tanh')

def _silu(x):
    return torch.nn.functional.silu(x)

def _sigmoid(x):
    return torch.sigmoid(x)

def _layernorm(x, axis=-1, eps=1e-05):
    m = x.mean(dim=axis, keepdim=True)
    v = x.var(dim=axis, keepdim=True, unbiased=False)
    return (x - m) / torch.sqrt(v + eps)

def _scatter_add(tgt, idx, src, axis=0):
    return tgt.clone().index_add_(axis, idx, src)

def _segment_sum(src, seg, n):
    out = torch.zeros((n,) + src.shape[1:], dtype=src.dtype)
    return out.index_add_(0, seg, src)

def _pad(x, pw):
    flat = tuple((v for pair in reversed(pw) for v in pair))
    return torch.nn.functional.pad(x, flat)
kernel_name = 'standalone__tree_speculative_verify_tree_attention_over_candidate_token_tree__prompt'

def setup_inputs():

    _w = lambda a: (lambda t: t.to(torch.bfloat16) if t.is_floating_point() else t)(torch.as_tensor(a))
    B, Hq, Hkv, T, C, D = (1, 32, 8, 2048, 2048, 128)
    tree_mask = torch.zeros((B, T, T), dtype=float)
    for b in range(B):
        parent = torch.zeros(T, dtype=torch.int64)
        for i in range(1, T):
            parent[i] = int(torch.randint(0, i, (1,)).item())
        for i in range(T):
            j = i
            tree_mask[b, i, j] = 1.0
            while j > 0:
                j = parent[j]
                tree_mask[b, i, j] = 1.0
    return {'q': _w((lambda *s: torch.randn(*s, dtype=torch.bfloat16) * 0.8)(B, Hq, T, D)), 'k_cache': _w((lambda *s: torch.randn(*s, dtype=torch.bfloat16) * 0.8)(B, Hkv, C, D)), 'v_cache': _w((lambda *s: torch.randn(*s, dtype=torch.bfloat16) * 0.05)(B, Hkv, C, D)), 'k_tree': _w((lambda *s: torch.randn(*s, dtype=torch.bfloat16) * 0.8)(B, Hkv, T, D)), 'v_tree': _w((lambda *s: torch.randn(*s, dtype=torch.bfloat16) * 0.05)(B, Hkv, T, D)), 'tree_mask': _w(tree_mask)}

def reference(q, k_cache, v_cache, k_tree, v_tree, tree_mask):
    B, Hq, T, D = q.shape
    Hkv, C = (k_cache.shape[1], k_cache.shape[2])
    rep = Hq // Hkv
    kc = (lambda x, n, axis: torch.repeat_interleave(x, n, dim=axis))(k_cache, rep, axis=1)
    vc = (lambda x, n, axis: torch.repeat_interleave(x, n, dim=axis))(v_cache, rep, axis=1)
    kt = (lambda x, n, axis: torch.repeat_interleave(x, n, dim=axis))(k_tree, rep, axis=1)
    vt = (lambda x, n, axis: torch.repeat_interleave(x, n, dim=axis))(v_tree, rep, axis=1)
    k = torch.concatenate([kc, kt], axis=2)
    v = torch.concatenate([vc, vt], axis=2)
    scale = D ** (-0.5)
    scores = torch.einsum('bhqd,bhkd->bhqk', q, k) * scale
    ctx_mask = torch.ones((B, 1, T, C), dtype=scores.dtype)
    tm = tree_mask[:, None, :, :].clone()
    full_mask = torch.concatenate([ctx_mask, tm], axis=-1)
    scores = scores + (1.0 - full_mask) * -1000000000.0
    p = _softmax(scores, axis=-1)
    return torch.einsum('bhqk,bhkd->bhqd', p, v)
```

```asm
; @launch kernel=prep_kernel grid=(128,1,1) block=(256,1,1) lds=64
; @launch kernel=standalone__tree_speculative_verify_tree_attention_over_candidate_token_tree__prompt_kernel grid=(256,1,1) block=(256,1,1) lds=131072
.amdgcn_target "amdgcn-amd-amdhsa--gfx950"
.text
.globl prep_kernel
.p2align 8
.type prep_kernel,@function
prep_kernel:
    s_cmp_ge_u32 s2, 128
    s_cbranch_scc1 LP_end
    s_load_dwordx2 s[4:5], s[0:1], 40
    s_load_dwordx2 s[8:9], s[0:1], 64
    s_waitcnt lgkmcnt(0)
    s_mov_b32 s6, 8388608
    s_mov_b32 s7, 0x00020000
    s_mov_b32 s10, 1052672
    s_mov_b32 s11, 0x00020000
    s_lshl_b32 s12, s2, 16
    v_lshlrev_b32 v1, 4, v0
    s_add_u32 s13, s12, 0
    buffer_load_dwordx4 v[16:19], v1, s[4:7], s13 offen
    s_add_u32 s13, s12, 4096
    buffer_load_dwordx4 v[20:23], v1, s[4:7], s13 offen
    s_add_u32 s13, s12, 8192
    buffer_load_dwordx4 v[24:27], v1, s[4:7], s13 offen
    s_add_u32 s13, s12, 12288
    buffer_load_dwordx4 v[28:31], v1, s[4:7], s13 offen
    s_add_u32 s13, s12, 16384
    buffer_load_dwordx4 v[32:35], v1, s[4:7], s13 offen
    s_add_u32 s13, s12, 20480
    buffer_load_dwordx4 v[36:39], v1, s[4:7], s13 offen
    s_add_u32 s13, s12, 24576
    buffer_load_dwordx4 v[40:43], v1, s[4:7], s13 offen
    s_add_u32 s13, s12, 28672
    buffer_load_dwordx4 v[44:47], v1, s[4:7], s13 offen
    s_add_u32 s13, s12, 32768
    buffer_load_dwordx4 v[48:51], v1, s[4:7], s13 offen
    s_add_u32 s13, s12, 36864
    buffer_load_dwordx4 v[52:55], v1, s[4:7], s13 offen
    s_add_u32 s13, s12, 40960
    buffer_load_dwordx4 v[56:59], v1, s[4:7], s13 offen
    s_add_u32 s13, s12, 45056
    buffer_load_dwordx4 v[60:63], v1, s[4:7], s13 offen
    s_add_u32 s13, s12, 49152
    buffer_load_dwordx4 v[64:67], v1, s[4:7], s13 offen
    s_add_u32 s13, s12, 53248
    buffer_load_dwordx4 v[68:71], v1, s[4:7], s13 offen
    s_add_u32 s13, s12, 57344
    buffer_load_dwordx4 v[72:75], v1, s[4:7], s13 offen
    s_add_u32 s13, s12, 61440
    buffer_load_dwordx4 v[76:79], v1, s[4:7], s13 offen
    v_mov_b32 v2, 0x3f803f80
    v_mov_b32 v8, 0
    v_mov_b32 v9, 0
    v_mov_b32 v10, 0
    v_mov_b32 v11, 0
    s_waitcnt vmcnt(0)
    v_pk_sub_i16 v3, v16, v2 clamp
    v_lshrrev_b32 v3, 15, v3
    s_mov_b32 s14, 0x10001
    v_and_or_b32 v8, v3, s14, v8
    v_pk_sub_i16 v3, v17, v2 clamp
    v_lshrrev_b32 v3, 15, v3
    s_mov_b32 s14, 0x10001
    v_and_or_b32 v9, v3, s14, v9
    v_pk_sub_i16 v3, v18, v2 clamp
    v_lshrrev_b32 v3, 15, v3
    s_mov_b32 s14, 0x10001
    v_and_or_b32 v10, v3, s14, v10
    v_pk_sub_i16 v3, v19, v2 clamp
    v_lshrrev_b32 v3, 15, v3
    s_mov_b32 s14, 0x10001
    v_and_or_b32 v11, v3, s14, v11
    v_pk_sub_i16 v3, v20, v2 clamp
    v_lshrrev_b32 v3, 14, v3
    s_mov_b32 s14, 0x20002
    v_and_or_b32 v8, v3, s14, v8
    v_pk_sub_i16 v3, v21, v2 clamp
    v_lshrrev_b32 v3, 14, v3
    s_mov_b32 s14, 0x20002
    v_and_or_b32 v9, v3, s14, v9
    v_pk_sub_i16 v3, v22, v2 clamp
    v_lshrrev_b32 v3, 14, v3
    s_mov_b32 s14, 0x20002
    v_and_or_b32 v10, v3, s14, v10
    v_pk_sub_i16 v3, v23, v2 clamp
    v_lshrrev_b32 v3, 14, v3
    s_mov_b32 s14, 0x20002
    v_and_or_b32 v11, v3, s14, v11
    v_pk_sub_i16 v3, v24, v2 clamp
    v_lshrrev_b32 v3, 13, v3
    s_mov_b32 s14, 0x40004
    v_and_or_b32 v8, v3, s14, v8
    v_pk_sub_i16 v3, v25, v2 clamp
    v_lshrrev_b32 v3, 13, v3
    s_mov_b32 s14, 0x40004
    v_and_or_b32 v9, v3, s14, v9
    v_pk_sub_i16 v3, v26, v2 clamp
    v_lshrrev_b32 v3, 13, v3
    s_mov_b32 s14, 0x40004
    v_and_or_b32 v10, v3, s14, v10
    v_pk_sub_i16 v3, v27, v2 clamp
    v_lshrrev_b32 v3, 13, v3
    s_mov_b32 s14, 0x40004
    v_and_or_b32 v11, v3, s14, v11
    v_pk_sub_i16 v3, v28, v2 clamp
    v_lshrrev_b32 v3, 12, v3
    s_mov_b32 s14, 0x80008
    v_and_or_b32 v8, v3, s14, v8
    v_pk_sub_i16 v3, v29, v2 clamp
    v_lshrrev_b32 v3, 12, v3
    s_mov_b32 s14, 0x80008
    v_and_or_b32 v9, v3, s14, v9
    v_pk_sub_i16 v3, v30, v2 clamp
    v_lshrrev_b32 v3, 12, v3
    s_mov_b32 s14, 0x80008
    v_and_or_b32 v10, v3, s14, v10
    v_pk_sub_i16 v3, v31, v2 clamp
    v_lshrrev_b32 v3, 12, v3
    s_mov_b32 s14, 0x80008
    v_and_or_b32 v11, v3, s14, v11
    v_pk_sub_i16 v3, v32, v2 clamp
    v_lshrrev_b32 v3, 11, v3
    s_mov_b32 s14, 0x100010
    v_and_or_b32 v8, v3, s14, v8
    v_pk_sub_i16 v3, v33, v2 clamp
    v_lshrrev_b32 v3, 11, v3
    s_mov_b32 s14, 0x100010
    v_and_or_b32 v9, v3, s14, v9
    v_pk_sub_i16 v3, v34, v2 clamp
    v_lshrrev_b32 v3, 11, v3
    s_mov_b32 s14, 0x100010
    v_and_or_b32 v10, v3, s14, v10
    v_pk_sub_i16 v3, v35, v2 clamp
    v_lshrrev_b32 v3, 11, v3
    s_mov_b32 s14, 0x100010
    v_and_or_b32 v11, v3, s14, v11
    v_pk_sub_i16 v3, v36, v2 clamp
    v_lshrrev_b32 v3, 10, v3
    s_mov_b32 s14, 0x200020
    v_and_or_b32 v8, v3, s14, v8
    v_pk_sub_i16 v3, v37, v2 clamp
    v_lshrrev_b32 v3, 10, v3
    s_mov_b32 s14, 0x200020
    v_and_or_b32 v9, v3, s14, v9
    v_pk_sub_i16 v3, v38, v2 clamp
    v_lshrrev_b32 v3, 10, v3
    s_mov_b32 s14, 0x200020
    v_and_or_b32 v10, v3, s14, v10
    v_pk_sub_i16 v3, v39, v2 clamp
    v_lshrrev_b32 v3, 10, v3
    s_mov_b32 s14, 0x200020
    v_and_or_b32 v11, v3, s14, v11
    v_pk_sub_i16 v3, v40, v2 clamp
    v_lshrrev_b32 v3, 9, v3
    s_mov_b32 s14, 0x400040
    v_and_or_b32 v8, v3, s14, v8
    v_pk_sub_i16 v3, v41, v2 clamp
    v_lshrrev_b32 v3, 9, v3
    s_mov_b32 s14, 0x400040
    v_and_or_b32 v9, v3, s14, v9
    v_pk_sub_i16 v3, v42, v2 clamp
    v_lshrrev_b32 v3, 9, v3
    s_mov_b32 s14, 0x400040
    v_and_or_b32 v10, v3, s14, v10
    v_pk_sub_i16 v3, v43, v2 clamp
    v_lshrrev_b32 v3, 9, v3
    s_mov_b32 s14, 0x400040
    v_and_or_b32 v11, v3, s14, v11
    v_pk_sub_i16 v3, v44, v2 clamp
    v_lshrrev_b32 v3, 8, v3
    s_mov_b32 s14, 0x800080
    v_and_or_b32 v8, v3, s14, v8
    v_pk_sub_i16 v3, v45, v2 clamp
    v_lshrrev_b32 v3, 8, v3
    s_mov_b32 s14, 0x800080
    v_and_or_b32 v9, v3, s14, v9
    v_pk_sub_i16 v3, v46, v2 clamp
    v_lshrrev_b32 v3, 8, v3
    s_mov_b32 s14, 0x800080
    v_and_or_b32 v10, v3, s14, v10
    v_pk_sub_i16 v3, v47, v2 clamp
    v_lshrrev_b32 v3, 8, v3
    s_mov_b32 s14, 0x800080
    v_and_or_b32 v11, v3, s14, v11
    v_pk_sub_i16 v3, v48, v2 clamp
    v_lshrrev_b32 v3, 7, v3
    s_mov_b32 s14, 0x1000100
    v_and_or_b32 v8, v3, s14, v8
    v_pk_sub_i16 v3, v49, v2 clamp
    v_lshrrev_b32 v3, 7, v3
    s_mov_b32 s14, 0x1000100
    v_and_or_b32 v9, v3, s14, v9
    v_pk_sub_i16 v3, v50, v2 clamp
    v_lshrrev_b32 v3, 7, v3
    s_mov_b32 s14, 0x1000100
    v_and_or_b32 v10, v3, s14, v10
    v_pk_sub_i16 v3, v51, v2 clamp
    v_lshrrev_b32 v3, 7, v3
    s_mov_b32 s14, 0x1000100
    v_and_or_b32 v11, v3, s14, v11
    v_pk_sub_i16 v3, v52, v2 clamp
    v_lshrrev_b32 v3, 6, v3
    s_mov_b32 s14, 0x2000200
    v_and_or_b32 v8, v3, s14, v8
    v_pk_sub_i16 v3, v53, v2 clamp
    v_lshrrev_b32 v3, 6, v3
    s_mov_b32 s14, 0x2000200
    v_and_or_b32 v9, v3, s14, v9
    v_pk_sub_i16 v3, v54, v2 clamp
    v_lshrrev_b32 v3, 6, v3
    s_mov_b32 s14, 0x2000200
    v_and_or_b32 v10, v3, s14, v10
    v_pk_sub_i16 v3, v55, v2 clamp
    v_lshrrev_b32 v3, 6, v3
    s_mov_b32 s14, 0x2000200
    v_and_or_b32 v11, v3, s14, v11
    v_pk_sub_i16 v3, v56, v2 clamp
    v_lshrrev_b32 v3, 5, v3
    s_mov_b32 s14, 0x4000400
    v_and_or_b32 v8, v3, s14, v8
    v_pk_sub_i16 v3, v57, v2 clamp
    v_lshrrev_b32 v3, 5, v3
    s_mov_b32 s14, 0x4000400
    v_and_or_b32 v9, v3, s14, v9
    v_pk_sub_i16 v3, v58, v2 clamp
    v_lshrrev_b32 v3, 5, v3
    s_mov_b32 s14, 0x4000400
    v_and_or_b32 v10, v3, s14, v10
    v_pk_sub_i16 v3, v59, v2 clamp
    v_lshrrev_b32 v3, 5, v3
    s_mov_b32 s14, 0x4000400
    v_and_or_b32 v11, v3, s14, v11
    v_pk_sub_i16 v3, v60, v2 clamp
    v_lshrrev_b32 v3, 4, v3
    s_mov_b32 s14, 0x8000800
    v_and_or_b32 v8, v3, s14, v8
    v_pk_sub_i16 v3, v61, v2 clamp
    v_lshrrev_b32 v3, 4, v3
    s_mov_b32 s14, 0x8000800
    v_and_or_b32 v9, v3, s14, v9
    v_pk_sub_i16 v3, v62, v2 clamp
    v_lshrrev_b32 v3, 4, v3
    s_mov_b32 s14, 0x8000800
    v_and_or_b32 v10, v3, s14, v10
    v_pk_sub_i16 v3, v63, v2 clamp
    v_lshrrev_b32 v3, 4, v3
    s_mov_b32 s14, 0x8000800
    v_and_or_b32 v11, v3, s14, v11
    v_pk_sub_i16 v3, v64, v2 clamp
    v_lshrrev_b32 v3, 3, v3
    s_mov_b32 s14, 0x10001000
    v_and_or_b32 v8, v3, s14, v8
    v_pk_sub_i16 v3, v65, v2 clamp
    v_lshrrev_b32 v3, 3, v3
    s_mov_b32 s14, 0x10001000
    v_and_or_b32 v9, v3, s14, v9
    v_pk_sub_i16 v3, v66, v2 clamp
    v_lshrrev_b32 v3, 3, v3
    s_mov_b32 s14, 0x10001000
    v_and_or_b32 v10, v3, s14, v10
    v_pk_sub_i16 v3, v67, v2 clamp
    v_lshrrev_b32 v3, 3, v3
    s_mov_b32 s14, 0x10001000
    v_and_or_b32 v11, v3, s14, v11
    v_pk_sub_i16 v3, v68, v2 clamp
    v_lshrrev_b32 v3, 2, v3
    s_mov_b32 s14, 0x20002000
    v_and_or_b32 v8, v3, s14, v8
    v_pk_sub_i16 v3, v69, v2 clamp
    v_lshrrev_b32 v3, 2, v3
    s_mov_b32 s14, 0x20002000
    v_and_or_b32 v9, v3, s14, v9
    v_pk_sub_i16 v3, v70, v2 clamp
    v_lshrrev_b32 v3, 2, v3
    s_mov_b32 s14, 0x20002000
    v_and_or_b32 v10, v3, s14, v10
    v_pk_sub_i16 v3, v71, v2 clamp
    v_lshrrev_b32 v3, 2, v3
    s_mov_b32 s14, 0x20002000
    v_and_or_b32 v11, v3, s14, v11
    v_pk_sub_i16 v3, v72, v2 clamp
    v_lshrrev_b32 v3, 1, v3
    s_mov_b32 s14, 0x40004000
    v_and_or_b32 v8, v3, s14, v8
    v_pk_sub_i16 v3, v73, v2 clamp
    v_lshrrev_b32 v3, 1, v3
    s_mov_b32 s14, 0x40004000
    v_and_or_b32 v9, v3, s14, v9
    v_pk_sub_i16 v3, v74, v2 clamp
    v_lshrrev_b32 v3, 1, v3
    s_mov_b32 s14, 0x40004000
    v_and_or_b32 v10, v3, s14, v10
    v_pk_sub_i16 v3, v75, v2 clamp
    v_lshrrev_b32 v3, 1, v3
    s_mov_b32 s14, 0x40004000
    v_and_or_b32 v11, v3, s14, v11
    v_pk_sub_i16 v3, v76, v2 clamp
    s_mov_b32 s14, 0x80008000
    v_and_or_b32 v8, v3, s14, v8
    v_pk_sub_i16 v3, v77, v2 clamp
    s_mov_b32 s14, 0x80008000
    v_and_or_b32 v9, v3, s14, v9
    v_pk_sub_i16 v3, v78, v2 clamp
    s_mov_b32 s14, 0x80008000
    v_and_or_b32 v10, v3, s14, v10
    v_pk_sub_i16 v3, v79, v2 clamp
    s_mov_b32 s14, 0x80008000
    v_and_or_b32 v11, v3, s14, v11
    v_not_b32 v8, v8
    v_not_b32 v9, v9
    v_not_b32 v10, v10
    v_not_b32 v11, v11
    v_and_b32 v16, 0xffff, v8
    v_lshrrev_b32 v17, 16, v8
    v_and_b32 v18, 0xffff, v9
    v_lshrrev_b32 v19, 16, v9
    v_and_b32 v20, 0xffff, v10
    v_lshrrev_b32 v21, 16, v10
    v_and_b32 v22, 0xffff, v11
    v_lshrrev_b32 v23, 16, v11
    s_mov_b32 s16, 0
    v_cmp_ne_u32 s[20:21], 0, v16
    v_cmp_ne_u32 s[22:23], 0, v17
    v_cmp_ne_u32 s[24:25], 0, v18
    v_cmp_ne_u32 s[26:27], 0, v19
    v_cmp_ne_u32 s[28:29], 0, v20
    v_cmp_ne_u32 s[30:31], 0, v21
    v_cmp_ne_u32 s[32:33], 0, v22
    v_cmp_ne_u32 s[34:35], 0, v23
    s_nop 1
    s_bcnt1_i32_b64 s17, s[20:21]
    s_add_u32 s16, s16, s17
    s_bcnt1_i32_b64 s17, s[22:23]
    s_add_u32 s16, s16, s17
    s_bcnt1_i32_b64 s17, s[24:25]
    s_add_u32 s16, s16, s17
    s_bcnt1_i32_b64 s17, s[26:27]
    s_add_u32 s16, s16, s17
    s_bcnt1_i32_b64 s17, s[28:29]
    s_add_u32 s16, s16, s17
    s_bcnt1_i32_b64 s17, s[30:31]
    s_add_u32 s16, s16, s17
    s_bcnt1_i32_b64 s17, s[32:33]
    s_add_u32 s16, s16, s17
    s_bcnt1_i32_b64 s17, s[34:35]
    s_add_u32 s16, s16, s17
    v_lshrrev_b32 v4, 6, v0
    s_nop 0
    v_readfirstlane_b32 s18, v4
    s_nop 3
    s_lshl_b32 s19, s18, 2
    v_mov_b32 v5, s19
    v_mov_b32 v6, s16
    ds_write_b32 v5, v6
    s_waitcnt lgkmcnt(0)
    s_barrier
    v_mov_b32 v5, 0
    ds_read_b128 v[24:27], v5
    s_waitcnt lgkmcnt(0)
    v_readfirstlane_b32 s40, v24
    v_readfirstlane_b32 s41, v25
    v_readfirstlane_b32 s42, v26
    v_readfirstlane_b32 s43, v27
    s_nop 3
    s_mov_b32 s44, 0
    s_cmp_gt_u32 s18, 0
    s_cselect_b32 s45, s40, 0
    s_add_u32 s44, s44, s45
    s_cmp_gt_u32 s18, 1
    s_cselect_b32 s45, s41, 0
    s_add_u32 s44, s44, s45
    s_cmp_gt_u32 s18, 2
    s_cselect_b32 s45, s42, 0
    s_add_u32 s44, s44, s45
    s_add_u32 s46, s40, s41
    s_add_u32 s46, s46, s42
    s_add_u32 s46, s46, s43
    s_lshl_b32 s47, s2, 13
    s_add_u32 s47, s47, 4096
    v_lshlrev_b32 v7, 3, v0
    v_mbcnt_lo_u32_b32 v4, s20, 0
    v_mbcnt_hi_u32_b32 v4, s21, v4
    v_add_u32 v4, s44, v4
    v_lshlrev_b32 v4, 2, v4
    v_add_u32 v5, 0, v7
    v_lshl_or_b32 v5, v16, 16, v5
    s_mov_b64 exec, s[20:21]
    s_nop 0
    buffer_store_dword v5, v4, s[8:11], s47 offen
    s_mov_b64 exec, -1
    s_bcnt1_i32_b64 s17, s[20:21]
    s_add_u32 s44, s44, s17
    v_mbcnt_lo_u32_b32 v4, s22, 0
    v_mbcnt_hi_u32_b32 v4, s23, v4
    v_add_u32 v4, s44, v4
    v_lshlrev_b32 v4, 2, v4
    v_add_u32 v5, 1, v7
    v_lshl_or_b32 v5, v17, 16, v5
    s_mov_b64 exec, s[22:23]
    s_nop 0
    buffer_store_dword v5, v4, s[8:11], s47 offen
    s_mov_b64 exec, -1
    s_bcnt1_i32_b64 s17, s[22:23]
    s_add_u32 s44, s44, s17
    v_mbcnt_lo_u32_b32 v4, s24, 0
    v_mbcnt_hi_u32_b32 v4, s25, v4
    v_add_u32 v4, s44, v4
    v_lshlrev_b32 v4, 2, v4
    v_add_u32 v5, 2, v7
    v_lshl_or_b32 v5, v18, 16, v5
    s_mov_b64 exec, s[24:25]
    s_nop 0
    buffer_store_dword v5, v4, s[8:11], s47 offen
    s_mov_b64 exec, -1
    s_bcnt1_i32_b64 s17, s[24:25]
    s_add_u32 s44, s44, s17
    v_mbcnt_lo_u32_b32 v4, s26, 0
    v_mbcnt_hi_u32_b32 v4, s27, v4
    v_add_u32 v4, s44, v4
    v_lshlrev_b32 v4, 2, v4
    v_add_u32 v5, 3, v7
    v_lshl_or_b32 v5, v19, 16, v5
    s_mov_b64 exec, s[26:27]
    s_nop 0
    buffer_store_dword v5, v4, s[8:11], s47 offen
    s_mov_b64 exec, -1
    s_bcnt1_i32_b64 s17, s[26:27]
    s_add_u32 s44, s44, s17
    v_mbcnt_lo_u32_b32 v4, s28, 0
    v_mbcnt_hi_u32_b32 v4, s29, v4
    v_add_u32 v4, s44, v4
    v_lshlrev_b32 v4, 2, v4
    v_add_u32 v5, 4, v7
    v_lshl_or_b32 v5, v20, 16, v5
    s_mov_b64 exec, s[28:29]
    s_nop 0
    buffer_store_dword v5, v4, s[8:11], s47 offen
    s_mov_b64 exec, -1
    s_bcnt1_i32_b64 s17, s[28:29]
    s_add_u32 s44, s44, s17
    v_mbcnt_lo_u32_b32 v4, s30, 0
    v_mbcnt_hi_u32_b32 v4, s31, v4
    v_add_u32 v4, s44, v4
    v_lshlrev_b32 v4, 2, v4
    v_add_u32 v5, 5, v7
    v_lshl_or_b32 v5, v21, 16, v5
    s_mov_b64 exec, s[30:31]
    s_nop 0
    buffer_store_dword v5, v4, s[8:11], s47 offen
    s_mov_b64 exec, -1
    s_bcnt1_i32_b64 s17, s[30:31]
    s_add_u32 s44, s44, s17
    v_mbcnt_lo_u32_b32 v4, s32, 0
    v_mbcnt_hi_u32_b32 v4, s33, v4
    v_add_u32 v4, s44, v4
    v_lshlrev_b32 v4, 2, v4
    v_add_u32 v5, 6, v7
    v_lshl_or_b32 v5, v22, 16, v5
    s_mov_b64 exec, s[32:33]
    s_nop 0
    buffer_store_dword v5, v4, s[8:11], s47 offen
    s_mov_b64 exec, -1
    s_bcnt1_i32_b64 s17, s[32:33]
    s_add_u32 s44, s44, s17
    v_mbcnt_lo_u32_b32 v4, s34, 0
    v_mbcnt_hi_u32_b32 v4, s35, v4
    v_add_u32 v4, s44, v4
    v_lshlrev_b32 v4, 2, v4
    v_add_u32 v5, 7, v7
    v_lshl_or_b32 v5, v23, 16, v5
    s_mov_b64 exec, s[34:35]
    s_nop 0
    buffer_store_dword v5, v4, s[8:11], s47 offen
    s_mov_b64 exec, -1
    s_bcnt1_i32_b64 s17, s[34:35]
    s_add_u32 s44, s44, s17
    s_add_u32 s48, s46, 31
    s_and_b32 s48, s48, 0xffffffe0
    v_add_u32 v4, s46, v0
    v_cmp_gt_u32 vcc, s48, v4
    s_and_saveexec_b64 s[50:51], vcc
    s_cbranch_execz LP_nopad
    v_lshlrev_b32 v4, 2, v4
    v_mov_b32 v5, 0
    buffer_store_dword v5, v4, s[8:11], s47 offen
LP_nopad:
    s_mov_b64 exec, s[50:51]
    v_cmp_eq_u32 vcc, 0, v0
    s_and_saveexec_b64 s[50:51], vcc
    s_cbranch_execz LP_end
    s_lshl_b32 s49, s2, 2
    v_mov_b32 v4, s49
    v_mov_b32 v5, s46
    buffer_store_dword v5, v4, s[8:11], 0 offen
LP_end:
    s_endpgm
.globl standalone__tree_speculative_verify_tree_attention_over_candidate_token_tree__prompt_kernel
.p2align 8
.type standalone__tree_speculative_verify_tree_attention_over_candidate_token_tree__prompt_kernel,@function
standalone__tree_speculative_verify_tree_attention_over_candidate_token_tree__prompt_kernel:
    s_cmp_ge_u32 s2, 256
    s_cbranch_scc1 L_end
    s_load_dwordx2 s[8:9], s[0:1], 0
    s_load_dwordx2 s[12:13], s[0:1], 8
    s_load_dwordx2 s[16:17], s[0:1], 16
    s_load_dwordx2 s[20:21], s[0:1], 24
    s_load_dwordx2 s[24:25], s[0:1], 32
    s_load_dwordx2 s[28:29], s[0:1], 48
    s_load_dwordx2 s[32:33], s[0:1], 64
    s_and_b32 s48, s2, 7
    s_lshr_b32 s49, s2, 3
    s_lshl_b32 s46, s48, 19
    v_and_b32 v1, 63, v0
    v_lshrrev_b32 v2, 6, v0
    s_nop 0
    v_readfirstlane_b32 s43, v2
    s_waitcnt lgkmcnt(0)
    s_add_u32 s12, s12, s46
    s_addc_u32 s13, s13, 0
    s_mov_b32 s14, 524288
    s_mov_b32 s15, 0x00020000
    s_add_u32 s16, s16, s46
    s_addc_u32 s17, s17, 0
    s_mov_b32 s18, 524288
    s_mov_b32 s19, 0x00020000
    s_add_u32 s20, s20, s46
    s_addc_u32 s21, s21, 0
    s_mov_b32 s22, 524288
    s_mov_b32 s23, 0x00020000
    s_add_u32 s24, s24, s46
    s_addc_u32 s25, s25, 0
    s_mov_b32 s26, 524288
    s_mov_b32 s27, 0x00020000
    s_mov_b32 s10, 16777216
    s_mov_b32 s11, 0x00020000
    s_mov_b32 s30, 16777216
    s_mov_b32 s31, 0x00020000
    s_mov_b32 s34, 1052672
    s_mov_b32 s35, 0x00020000
    s_mov_b32 s36, 0x3e0293ee
    s_mov_b32 s37, 0x41000000
    s_mov_b32 s39, 0
    s_lshl_b32 s44, s43, 11
    s_mov_b32 s38, s44
    v_and_b32 v2, 31, v1
    v_lshrrev_b32 v3, 2, v2
    v_and_b32 v4, 3, v2
    s_lshl_b32 s46, s48, 2
    s_lshl_b32 s47, s49, 6
    s_lshl_b32 s51, s43, 4
    s_add_u32 s47, s47, s51
    v_add_u32 v4, s46, v4
    v_lshlrev_b32 v4, 11, v4
    v_add_u32 v3, s47, v3
    v_add_u32 v3, v3, v4
    v_lshlrev_b32 v3, 8, v3
    v_lshrrev_b32 v5, 5, v1
    v_lshlrev_b32 v6, 4, v5
    v_add_u32 v187, v3, v6
    v_add_u32 v188, 2048, v187
    buffer_load_dwordx4 v[16:19], v187, s[8:11], 0 offen offset:0
    buffer_load_dwordx4 v[20:23], v187, s[8:11], 0 offen offset:32
    buffer_load_dwordx4 v[24:27], v187, s[8:11], 0 offen offset:64
    buffer_load_dwordx4 v[28:31], v187, s[8:11], 0 offen offset:96
    buffer_load_dwordx4 v[32:35], v187, s[8:11], 0 offen offset:128
    buffer_load_dwordx4 v[36:39], v187, s[8:11], 0 offen offset:160
    buffer_load_dwordx4 v[40:43], v187, s[8:11], 0 offen offset:192
    buffer_load_dwordx4 v[44:47], v187, s[8:11], 0 offen offset:224
    buffer_load_dwordx4 v[48:51], v188, s[8:11], 0 offen offset:0
    buffer_load_dwordx4 v[52:55], v188, s[8:11], 0 offen offset:32
    buffer_load_dwordx4 v[56:59], v188, s[8:11], 0 offen offset:64
    buffer_load_dwordx4 v[60:63], v188, s[8:11], 0 offen offset:96
    buffer_load_dwordx4 v[64:67], v188, s[8:11], 0 offen offset:128
    buffer_load_dwordx4 v[68:71], v188, s[8:11], 0 offen offset:160
    buffer_load_dwordx4 v[72:75], v188, s[8:11], 0 offen offset:192
    buffer_load_dwordx4 v[76:79], v188, s[8:11], 0 offen offset:224
    v_lshrrev_b32 v2, 4, v1
    v_and_b32 v3, 15, v1
    v_lshlrev_b32 v4, 8, v2
    s_and_b32 s46, s43, 1
    s_lshl_b32 s46, s46, 3
    v_add_u32 v5, s46, v2
    v_xor_b32 v5, v3, v5
    v_lshl_add_u32 v184, v5, 4, v4
    v_add_u32 v5, s46, v2
    v_add_u32 v5, 4, v5
    v_xor_b32 v5, v3, v5
    v_lshl_add_u32 v185, v5, 4, v4
    v_add_u32 v5, 0, v2
    v_xor_b32 v5, v3, v5
    v_lshlrev_b32 v240, 4, v5
    v_add_u32 v5, 4, v2
    v_xor_b32 v5, v3, v5
    v_lshlrev_b32 v241, 4, v5
    v_add_u32 v5, 8, v2
    v_xor_b32 v5, v3, v5
    v_lshlrev_b32 v242, 4, v5
    v_add_u32 v5, 12, v2
    v_xor_b32 v5, v3, v5
    v_lshlrev_b32 v243, 4, v5
    v_lshlrev_b32 v5, 2, v2
    v_xor_b32 v5, v3, v5
    v_lshl_add_u32 v186, v5, 4, v4
    s_add_u32 m0, s44, 0
    s_nop 0
    buffer_load_dwordx4 v184, s[12:15], s38 offen lds
    buffer_load_dwordx4 v185, s[12:15], s38 offen offset:1024 lds
    s_add_u32 m0, s44, 8192
    s_nop 0
    buffer_load_dwordx4 v186, s[16:19], s38 offen lds
    buffer_load_dwordx4 v186, s[16:19], s38 offen offset:1024 lds
    s_add_u32 s38, s38, 8192
    s_add_u32 m0, s44, 16384
    s_nop 0
    buffer_load_dwordx4 v184, s[12:15], s38 offen lds
    buffer_load_dwordx4 v185, s[12:15], s38 offen offset:1024 lds
    s_add_u32 m0, s44, 24576
    s_nop 0
    buffer_load_dwordx4 v186, s[16:19], s38 offen lds
    buffer_load_dwordx4 v186, s[16:19], s38 offen offset:1024 lds
    s_add_u32 s38, s38, 8192
    s_add_u32 m0, s44, 32768
    s_nop 0
    buffer_load_dwordx4 v184, s[12:15], s38 offen lds
    buffer_load_dwordx4 v185, s[12:15], s38 offen offset:1024 lds
    s_add_u32 m0, s44, 40960
    s_nop 0
    buffer_load_dwordx4 v186, s[16:19], s38 offen lds
    buffer_load_dwordx4 v186, s[16:19], s38 offen offset:1024 lds
    s_add_u32 s38, s38, 8192
    s_add_u32 m0, s44, 49152
    s_nop 0
    buffer_load_dwordx4 v184, s[12:15], s38 offen lds
    buffer_load_dwordx4 v185, s[12:15], s38 offen offset:1024 lds
    s_add_u32 m0, s44, 57344
    s_nop 0
    buffer_load_dwordx4 v186, s[16:19], s38 offen lds
    buffer_load_dwordx4 v186, s[16:19], s38 offen offset:1024 lds
    s_add_u32 s38, s38, 8192
    s_add_u32 m0, s44, 65536
    s_nop 0
    buffer_load_dwordx4 v184, s[12:15], s38 offen lds
    buffer_load_dwordx4 v185, s[12:15], s38 offen offset:1024 lds
    s_add_u32 m0, s44, 73728
    s_nop 0
    buffer_load_dwordx4 v186, s[16:19], s38 offen lds
    buffer_load_dwordx4 v186, s[16:19], s38 offen offset:1024 lds
    s_add_u32 s38, s38, 8192
    s_add_u32 m0, s44, 81920
    s_nop 0
    buffer_load_dwordx4 v184, s[12:15], s38 offen lds
    buffer_load_dwordx4 v185, s[12:15], s38 offen offset:1024 lds
    s_add_u32 m0, s44, 90112
    s_nop 0
    buffer_load_dwordx4 v186, s[16:19], s38 offen lds
    buffer_load_dwordx4 v186, s[16:19], s38 offen offset:1024 lds
    s_add_u32 s38, s38, 8192
    v_and_b32 v2, 31, v1
    v_lshrrev_b32 v3, 5, v1
    v_and_b32 v4, 15, v2
    v_xor_b32 v4, v4, v3
    v_lshlrev_b32 v2, 8, v2
    v_xor_b32 v5, 0, v4
    v_lshl_add_u32 v144, v5, 4, v2
    v_add_u32 v152, 0x10000, v144
    v_xor_b32 v5, 2, v4
    v_lshl_add_u32 v145, v5, 4, v2
    v_add_u32 v153, 0x10000, v145
    v_xor_b32 v5, 4, v4
    v_lshl_add_u32 v146, v5, 4, v2
    v_add_u32 v154, 0x10000, v146
    v_xor_b32 v5, 6, v4
    v_lshl_add_u32 v147, v5, 4, v2
    v_add_u32 v155, 0x10000, v147
    v_xor_b32 v5, 8, v4
    v_lshl_add_u32 v148, v5, 4, v2
    v_add_u32 v156, 0x10000, v148
    v_xor_b32 v5, 10, v4
    v_lshl_add_u32 v149, v5, 4, v2
    v_add_u32 v157, 0x10000, v149
    v_xor_b32 v5, 12, v4
    v_lshl_add_u32 v150, v5, 4, v2
    v_add_u32 v158, 0x10000, v150
    v_xor_b32 v5, 14, v4
    v_lshl_add_u32 v151, v5, 4, v2
    v_add_u32 v159, 0x10000, v151
    v_lshrrev_b32 v2, 4, v1
    v_bfe_u32 v3, v1, 2, 2
    v_and_b32 v4, 3, v1
    v_lshrrev_b32 v5, 1, v2
    v_lshl_add_u32 v5, v5, 2, v3
    v_lshlrev_b32 v5, 8, v5
    v_and_b32 v6, 1, v2
    v_lshlrev_b32 v6, 1, v6
    v_lshrrev_b32 v7, 1, v4
    v_add_u32 v6, v6, v7
    v_and_b32 v7, 1, v4
    v_lshlrev_b32 v7, 3, v7
    v_add_u32 v5, v5, v7
    v_xor_b32 v8, 0, v3
    v_lshl_add_u32 v8, v8, 2, v6
    v_lshl_add_u32 v160, v8, 4, v5
    v_add_u32 v164, 0x10000, v160
    v_xor_b32 v8, 1, v3
    v_lshl_add_u32 v8, v8, 2, v6
    v_lshl_add_u32 v161, v8, 4, v5
    v_add_u32 v165, 0x10000, v161
    v_xor_b32 v8, 2, v3
    v_lshl_add_u32 v8, v8, 2, v6
    v_lshl_add_u32 v162, v8, 4, v5
    v_add_u32 v166, 0x10000, v162
    v_xor_b32 v8, 3, v3
    v_lshl_add_u32 v8, v8, 2, v6
    v_lshl_add_u32 v163, v8, 4, v5
    v_add_u32 v167, 0x10000, v163
    s_lshl_b32 s46, s43, 14
    v_add_u32 v224, s46, v144
    v_add_u32 v225, s46, v145
    v_add_u32 v226, s46, v146
    v_add_u32 v227, s46, v147
    v_add_u32 v228, s46, v148
    v_add_u32 v229, s46, v149
    v_add_u32 v230, s46, v150
    v_add_u32 v231, s46, v151
    v_add_u32 v232, s46, v160
    v_add_u32 v233, s46, v161
    v_add_u32 v234, s46, v162
    v_add_u32 v235, s46, v163
    v_bfe_u32 v2, v1, 2, 3
    v_add_u32 v236, 16, v2
    v_add_u32 v237, 24, v2
    v_mov_b32 v238, 0xf149f2ca
    v_mov_b32 v168, 0
    v_mov_b32 v169, 0
    v_mov_b32 v170, 1.0
    v_mov_b32 v173, 0
    v_mov_b32 v174, 0
    v_mov_b32 v175, 1.0
    v_accvgpr_write_b32 a0, 0
    v_accvgpr_write_b32 a1, 0
    v_accvgpr_write_b32 a2, 0
    v_accvgpr_write_b32 a3, 0
    v_accvgpr_write_b32 a4, 0
    v_accvgpr_write_b32 a5, 0
    v_accvgpr_write_b32 a6, 0
    v_accvgpr_write_b32 a7, 0
    v_accvgpr_write_b32 a8, 0
    v_accvgpr_write_b32 a9, 0
    v_accvgpr_write_b32 a10, 0
    v_accvgpr_write_b32 a11, 0
    v_accvgpr_write_b32 a12, 0
    v_accvgpr_write_b32 a13, 0
    v_accvgpr_write_b32 a14, 0
    v_accvgpr_write_b32 a15, 0
    v_accvgpr_write_b32 a16, 0
    v_accvgpr_write_b32 a17, 0
    v_accvgpr_write_b32 a18, 0
    v_accvgpr_write_b32 a19, 0
    v_accvgpr_write_b32 a20, 0
    v_accvgpr_write_b32 a21, 0
    v_accvgpr_write_b32 a22, 0
    v_accvgpr_write_b32 a23, 0
    v_accvgpr_write_b32 a24, 0
    v_accvgpr_write_b32 a25, 0
    v_accvgpr_write_b32 a26, 0
    v_accvgpr_write_b32 a27, 0
    v_accvgpr_write_b32 a28, 0
    v_accvgpr_write_b32 a29, 0
    v_accvgpr_write_b32 a30, 0
    v_accvgpr_write_b32 a31, 0
    v_accvgpr_write_b32 a32, 0
    v_accvgpr_write_b32 a33, 0
    v_accvgpr_write_b32 a34, 0
    v_accvgpr_write_b32 a35, 0
    v_accvgpr_write_b32 a36, 0
    v_accvgpr_write_b32 a37, 0
    v_accvgpr_write_b32 a38, 0
    v_accvgpr_write_b32 a39, 0
    v_accvgpr_write_b32 a40, 0
    v_accvgpr_write_b32 a41, 0
    v_accvgpr_write_b32 a42, 0
    v_accvgpr_write_b32 a43, 0
    v_accvgpr_write_b32 a44, 0
    v_accvgpr_write_b32 a45, 0
    v_accvgpr_write_b32 a46, 0
    v_accvgpr_write_b32 a47, 0
    v_accvgpr_write_b32 a48, 0
    v_accvgpr_write_b32 a49, 0
    v_accvgpr_write_b32 a50, 0
    v_accvgpr_write_b32 a51, 0
    v_accvgpr_write_b32 a52, 0
    v_accvgpr_write_b32 a53, 0
    v_accvgpr_write_b32 a54, 0
    v_accvgpr_write_b32 a55, 0
    v_accvgpr_write_b32 a56, 0
    v_accvgpr_write_b32 a57, 0
    v_accvgpr_write_b32 a58, 0
    v_accvgpr_write_b32 a59, 0
    v_accvgpr_write_b32 a60, 0
    v_accvgpr_write_b32 a61, 0
    v_accvgpr_write_b32 a62, 0
    v_accvgpr_write_b32 a63, 0
    v_accvgpr_write_b32 a64, 0
    v_accvgpr_write_b32 a65, 0
    v_accvgpr_write_b32 a66, 0
    v_accvgpr_write_b32 a67, 0
    v_accvgpr_write_b32 a68, 0
    v_accvgpr_write_b32 a69, 0
    v_accvgpr_write_b32 a70, 0
    v_accvgpr_write_b32 a71, 0
    v_accvgpr_write_b32 a72, 0
    v_accvgpr_write_b32 a73, 0
    v_accvgpr_write_b32 a74, 0
    v_accvgpr_write_b32 a75, 0
    v_accvgpr_write_b32 a76, 0
    v_accvgpr_write_b32 a77, 0
    v_accvgpr_write_b32 a78, 0
    v_accvgpr_write_b32 a79, 0
    v_accvgpr_write_b32 a80, 0
    v_accvgpr_write_b32 a81, 0
    v_accvgpr_write_b32 a82, 0
    v_accvgpr_write_b32 a83, 0
    v_accvgpr_write_b32 a84, 0
    v_accvgpr_write_b32 a85, 0
    v_accvgpr_write_b32 a86, 0
    v_accvgpr_write_b32 a87, 0
    v_accvgpr_write_b32 a88, 0
    v_accvgpr_write_b32 a89, 0
    v_accvgpr_write_b32 a90, 0
    v_accvgpr_write_b32 a91, 0
    v_accvgpr_write_b32 a92, 0
    v_accvgpr_write_b32 a93, 0
    v_accvgpr_write_b32 a94, 0
    v_accvgpr_write_b32 a95, 0
    v_accvgpr_write_b32 a96, 0
    v_accvgpr_write_b32 a97, 0
    v_accvgpr_write_b32 a98, 0
    v_accvgpr_write_b32 a99, 0
    v_accvgpr_write_b32 a100, 0
    v_accvgpr_write_b32 a101, 0
    v_accvgpr_write_b32 a102, 0
    v_accvgpr_write_b32 a103, 0
    v_accvgpr_write_b32 a104, 0
    v_accvgpr_write_b32 a105, 0
    v_accvgpr_write_b32 a106, 0
    v_accvgpr_write_b32 a107, 0
    v_accvgpr_write_b32 a108, 0
    v_accvgpr_write_b32 a109, 0
    v_accvgpr_write_b32 a110, 0
    v_accvgpr_write_b32 a111, 0
    v_accvgpr_write_b32 a112, 0
    v_accvgpr_write_b32 a113, 0
    v_accvgpr_write_b32 a114, 0
    v_accvgpr_write_b32 a115, 0
    v_accvgpr_write_b32 a116, 0
    v_accvgpr_write_b32 a117, 0
    v_accvgpr_write_b32 a118, 0
    v_accvgpr_write_b32 a119, 0
    v_accvgpr_write_b32 a120, 0
    v_accvgpr_write_b32 a121, 0
    v_accvgpr_write_b32 a122, 0
    v_accvgpr_write_b32 a123, 0
    v_accvgpr_write_b32 a124, 0
    v_accvgpr_write_b32 a125, 0
    v_accvgpr_write_b32 a126, 0
    v_accvgpr_write_b32 a127, 0
    s_waitcnt vmcnt(24)
    v_lshlrev_b32 v2, 16, v16
    v_and_b32 v3, 0xffff0000, v16
    v_mul_f32 v2, s36, v2
    v_mul_f32 v3, s36, v3
    v_cvt_pk_bf16_f32 v2, v2, v3
    v_accvgpr_write_b32 a128, v2
    v_lshlrev_b32 v4, 16, v17
    v_and_b32 v5, 0xffff0000, v17
    v_mul_f32 v4, s36, v4
    v_mul_f32 v5, s36, v5
    v_cvt_pk_bf16_f32 v4, v4, v5
    v_accvgpr_write_b32 a129, v4
    v_lshlrev_b32 v6, 16, v18
    v_and_b32 v7, 0xffff0000, v18
    v_mul_f32 v6, s36, v6
    v_mul_f32 v7, s36, v7
    v_cvt_pk_bf16_f32 v6, v6, v7
    v_accvgpr_write_b32 a130, v6
    v_lshlrev_b32 v8, 16, v19
    v_and_b32 v9, 0xffff0000, v19
    v_mul_f32 v8, s36, v8
    v_mul_f32 v9, s36, v9
    v_cvt_pk_bf16_f32 v8, v8, v9
    v_accvgpr_write_b32 a131, v8
    v_lshlrev_b32 v2, 16, v20
    v_and_b32 v3, 0xffff0000, v20
    v_mul_f32 v2, s36, v2
    v_mul_f32 v3, s36, v3
    v_cvt_pk_bf16_f32 v2, v2, v3
    v_accvgpr_write_b32 a132, v2
    v_lshlrev_b32 v4, 16, v21
    v_and_b32 v5, 0xffff0000, v21
    v_mul_f32 v4, s36, v4
    v_mul_f32 v5, s36, v5
    v_cvt_pk_bf16_f32 v4, v4, v5
    v_accvgpr_write_b32 a133, v4
    v_lshlrev_b32 v6, 16, v22
    v_and_b32 v7, 0xffff0000, v22
    v_mul_f32 v6, s36, v6
    v_mul_f32 v7, s36, v7
    v_cvt_pk_bf16_f32 v6, v6, v7
    v_accvgpr_write_b32 a134, v6
    v_lshlrev_b32 v8, 16, v23
    v_and_b32 v9, 0xffff0000, v23
    v_mul_f32 v8, s36, v8
    v_mul_f32 v9, s36, v9
    v_cvt_pk_bf16_f32 v8, v8, v9
    v_accvgpr_write_b32 a135, v8
    v_lshlrev_b32 v2, 16, v24
    v_and_b32 v3, 0xffff0000, v24
    v_mul_f32 v2, s36, v2
    v_mul_f32 v3, s36, v3
    v_cvt_pk_bf16_f32 v2, v2, v3
    v_accvgpr_write_b32 a136, v2
    v_lshlrev_b32 v4, 16, v25
    v_and_b32 v5, 0xffff0000, v25
    v_mul_f32 v4, s36, v4
    v_mul_f32 v5, s36, v5
    v_cvt_pk_bf16_f32 v4, v4, v5
    v_accvgpr_write_b32 a137, v4
    v_lshlrev_b32 v6, 16, v26
    v_and_b32 v7, 0xffff0000, v26
    v_mul_f32 v6, s36, v6
    v_mul_f32 v7, s36, v7
    v_cvt_pk_bf16_f32 v6, v6, v7
    v_accvgpr_write_b32 a138, v6
    v_lshlrev_b32 v8, 16, v27
    v_and_b32 v9, 0xffff0000, v27
    v_mul_f32 v8, s36, v8
    v_mul_f32 v9, s36, v9
    v_cvt_pk_bf16_f32 v8, v8, v9
    v_accvgpr_write_b32 a139, v8
    v_lshlrev_b32 v2, 16, v28
    v_and_b32 v3, 0xffff0000, v28
    v_mul_f32 v2, s36, v2
    v_mul_f32 v3, s36, v3
    v_cvt_pk_bf16_f32 v2, v2, v3
    v_accvgpr_write_b32 a140, v2
    v_lshlrev_b32 v4, 16, v29
    v_and_b32 v5, 0xffff0000, v29
    v_mul_f32 v4, s36, v4
    v_mul_f32 v5, s36, v5
    v_cvt_pk_bf16_f32 v4, v4, v5
    v_accvgpr_write_b32 a141, v4
    v_lshlrev_b32 v6, 16, v30
    v_and_b32 v7, 0xffff0000, v30
    v_mul_f32 v6, s36, v6
    v_mul_f32 v7, s36, v7
    v_cvt_pk_bf16_f32 v6, v6, v7
    v_accvgpr_write_b32 a142, v6
    v_lshlrev_b32 v8, 16, v31
    v_and_b32 v9, 0xffff0000, v31
    v_mul_f32 v8, s36, v8
    v_mul_f32 v9, s36, v9
    v_cvt_pk_bf16_f32 v8, v8, v9
    v_accvgpr_write_b32 a143, v8
    v_lshlrev_b32 v2, 16, v32
    v_and_b32 v3, 0xffff0000, v32
    v_mul_f32 v2, s36, v2
    v_mul_f32 v3, s36, v3
    v_cvt_pk_bf16_f32 v2, v2, v3
    v_accvgpr_write_b32 a144, v2
    v_lshlrev_b32 v4, 16, v33
    v_and_b32 v5, 0xffff0000, v33
    v_mul_f32 v4, s36, v4
    v_mul_f32 v5, s36, v5
    v_cvt_pk_bf16_f32 v4, v4, v5
    v_accvgpr_write_b32 a145, v4
    v_lshlrev_b32 v6, 16, v34
    v_and_b32 v7, 0xffff0000, v34
    v_mul_f32 v6, s36, v6
    v_mul_f32 v7, s36, v7
    v_cvt_pk_bf16_f32 v6, v6, v7
    v_accvgpr_write_b32 a146, v6
    v_lshlrev_b32 v8, 16, v35
    v_and_b32 v9, 0xffff0000, v35
    v_mul_f32 v8, s36, v8
    v_mul_f32 v9, s36, v9
    v_cvt_pk_bf16_f32 v8, v8, v9
    v_accvgpr_write_b32 a147, v8
    v_lshlrev_b32 v2, 16, v36
    v_and_b32 v3, 0xffff0000, v36
    v_mul_f32 v2, s36, v2
    v_mul_f32 v3, s36, v3
    v_cvt_pk_bf16_f32 v2, v2, v3
    v_accvgpr_write_b32 a148, v2
    v_lshlrev_b32 v4, 16, v37
    v_and_b32 v5, 0xffff0000, v37
    v_mul_f32 v4, s36, v4
    v_mul_f32 v5, s36, v5
    v_cvt_pk_bf16_f32 v4, v4, v5
    v_accvgpr_write_b32 a149, v4
    v_lshlrev_b32 v6, 16, v38
    v_and_b32 v7, 0xffff0000, v38
    v_mul_f32 v6, s36, v6
    v_mul_f32 v7, s36, v7
    v_cvt_pk_bf16_f32 v6, v6, v7
    v_accvgpr_write_b32 a150, v6
    v_lshlrev_b32 v8, 16, v39
    v_and_b32 v9, 0xffff0000, v39
    v_mul_f32 v8, s36, v8
    v_mul_f32 v9, s36, v9
    v_cvt_pk_bf16_f32 v8, v8, v9
    v_accvgpr_write_b32 a151, v8
    v_lshlrev_b32 v2, 16, v40
    v_and_b32 v3, 0xffff0000, v40
    v_mul_f32 v2, s36, v2
    v_mul_f32 v3, s36, v3
    v_cvt_pk_bf16_f32 v2, v2, v3
    v_accvgpr_write_b32 a152, v2
    v_lshlrev_b32 v4, 16, v41
    v_and_b32 v5, 0xffff0000, v41
    v_mul_f32 v4, s36, v4
    v_mul_f32 v5, s36, v5
    v_cvt_pk_bf16_f32 v4, v4, v5
    v_accvgpr_write_b32 a153, v4
    v_lshlrev_b32 v6, 16, v42
    v_and_b32 v7, 0xffff0000, v42
    v_mul_f32 v6, s36, v6
    v_mul_f32 v7, s36, v7
    v_cvt_pk_bf16_f32 v6, v6, v7
    v_accvgpr_write_b32 a154, v6
    v_lshlrev_b32 v8, 16, v43
    v_and_b32 v9, 0xffff0000, v43
    v_mul_f32 v8, s36, v8
    v_mul_f32 v9, s36, v9
    v_cvt_pk_bf16_f32 v8, v8, v9
    v_accvgpr_write_b32 a155, v8
    v_lshlrev_b32 v2, 16, v44
    v_and_b32 v3, 0xffff0000, v44
    v_mul_f32 v2, s36, v2
    v_mul_f32 v3, s36, v3
    v_cvt_pk_bf16_f32 v2, v2, v3
    v_accvgpr_write_b32 a156, v2
    v_lshlrev_b32 v4, 16, v45
    v_and_b32 v5, 0xffff0000, v45
    v_mul_f32 v4, s36, v4
    v_mul_f32 v5, s36, v5
    v_cvt_pk_bf16_f32 v4, v4, v5
    v_accvgpr_write_b32 a157, v4
    v_lshlrev_b32 v6, 16, v46
    v_and_b32 v7, 0xffff0000, v46
    v_mul_f32 v6, s36, v6
    v_mul_f32 v7, s36, v7
    v_cvt_pk_bf16_f32 v6, v6, v7
    v_accvgpr_write_b32 a158, v6
    v_lshlrev_b32 v8, 16, v47
    v_and_b32 v9, 0xffff0000, v47
    v_mul_f32 v8, s36, v8
    v_mul_f32 v9, s36, v9
    v_cvt_pk_bf16_f32 v8, v8, v9
    v_accvgpr_write_b32 a159, v8
    v_lshlrev_b32 v2, 16, v48
    v_and_b32 v3, 0xffff0000, v48
    v_mul_f32 v2, s36, v2
    v_mul_f32 v3, s36, v3
    v_cvt_pk_bf16_f32 v2, v2, v3
    v_accvgpr_write_b32 a160, v2
    v_lshlrev_b32 v4, 16, v49
    v_and_b32 v5, 0xffff0000, v49
    v_mul_f32 v4, s36, v4
    v_mul_f32 v5, s36, v5
    v_cvt_pk_bf16_f32 v4, v4, v5
    v_accvgpr_write_b32 a161, v4
    v_lshlrev_b32 v6, 16, v50
    v_and_b32 v7, 0xffff0000, v50
    v_mul_f32 v6, s36, v6
    v_mul_f32 v7, s36, v7
    v_cvt_pk_bf16_f32 v6, v6, v7
    v_accvgpr_write_b32 a162, v6
    v_lshlrev_b32 v8, 16, v51
    v_and_b32 v9, 0xffff0000, v51
    v_mul_f32 v8, s36, v8
    v_mul_f32 v9, s36, v9
    v_cvt_pk_bf16_f32 v8, v8, v9
    v_accvgpr_write_b32 a163, v8
    v_lshlrev_b32 v2, 16, v52
    v_and_b32 v3, 0xffff0000, v52
    v_mul_f32 v2, s36, v2
    v_mul_f32 v3, s36, v3
    v_cvt_pk_bf16_f32 v2, v2, v3
    v_accvgpr_write_b32 a164, v2
    v_lshlrev_b32 v4, 16, v53
    v_and_b32 v5, 0xffff0000, v53
    v_mul_f32 v4, s36, v4
    v_mul_f32 v5, s36, v5
    v_cvt_pk_bf16_f32 v4, v4, v5
    v_accvgpr_write_b32 a165, v4
    v_lshlrev_b32 v6, 16, v54
    v_and_b32 v7, 0xffff0000, v54
    v_mul_f32 v6, s36, v6
    v_mul_f32 v7, s36, v7
    v_cvt_pk_bf16_f32 v6, v6, v7
    v_accvgpr_write_b32 a166, v6
    v_lshlrev_b32 v8, 16, v55
    v_and_b32 v9, 0xffff0000, v55
    v_mul_f32 v8, s36, v8
    v_mul_f32 v9, s36, v9
    v_cvt_pk_bf16_f32 v8, v8, v9
    v_accvgpr_write_b32 a167, v8
    v_lshlrev_b32 v2, 16, v56
    v_and_b32 v3, 0xffff0000, v56
    v_mul_f32 v2, s36, v2
    v_mul_f32 v3, s36, v3
    v_cvt_pk_bf16_f32 v2, v2, v3
    v_accvgpr_write_b32 a168, v2
    v_lshlrev_b32 v4, 16, v57
    v_and_b32 v5, 0xffff0000, v57
    v_mul_f32 v4, s36, v4
    v_mul_f32 v5, s36, v5
    v_cvt_pk_bf16_f32 v4, v4, v5
    v_accvgpr_write_b32 a169, v4
    v_lshlrev_b32 v6, 16, v58
    v_and_b32 v7, 0xffff0000, v58
    v_mul_f32 v6, s36, v6
    v_mul_f32 v7, s36, v7
    v_cvt_pk_bf16_f32 v6, v6, v7
    v_accvgpr_write_b32 a170, v6
    v_lshlrev_b32 v8, 16, v59
    v_and_b32 v9, 0xffff0000, v59
    v_mul_f32 v8, s36, v8
    v_mul_f32 v9, s36, v9
    v_cvt_pk_bf16_f32 v8, v8, v9
    v_accvgpr_write_b32 a171, v8
    v_lshlrev_b32 v2, 16, v60
    v_and_b32 v3, 0xffff0000, v60
    v_mul_f32 v2, s36, v2
    v_mul_f32 v3, s36, v3
    v_cvt_pk_bf16_f32 v2, v2, v3
    v_accvgpr_write_b32 a172, v2
    v_lshlrev_b32 v4, 16, v61
    v_and_b32 v5, 0xffff0000, v61
    v_mul_f32 v4, s36, v4
    v_mul_f32 v5, s36, v5
    v_cvt_pk_bf16_f32 v4, v4, v5
    v_accvgpr_write_b32 a173, v4
    v_lshlrev_b32 v6, 16, v62
    v_and_b32 v7, 0xffff0000, v62
    v_mul_f32 v6, s36, v6
    v_mul_f32 v7, s36, v7
    v_cvt_pk_bf16_f32 v6, v6, v7
    v_accvgpr_write_b32 a174, v6
    v_lshlrev_b32 v8, 16, v63
    v_and_b32 v9, 0xffff0000, v63
    v_mul_f32 v8, s36, v8
    v_mul_f32 v9, s36, v9
    v_cvt_pk_bf16_f32 v8, v8, v9
    v_accvgpr_write_b32 a175, v8
    v_lshlrev_b32 v2, 16, v64
    v_and_b32 v3, 0xffff0000, v64
    v_mul_f32 v2, s36, v2
    v_mul_f32 v3, s36, v3
    v_cvt_pk_bf16_f32 v2, v2, v3
    v_accvgpr_write_b32 a176, v2
    v_lshlrev_b32 v4, 16, v65
    v_and_b32 v5, 0xffff0000, v65
    v_mul_f32 v4, s36, v4
    v_mul_f32 v5, s36, v5
    v_cvt_pk_bf16_f32 v4, v4, v5
    v_accvgpr_write_b32 a177, v4
    v_lshlrev_b32 v6, 16, v66
    v_and_b32 v7, 0xffff0000, v66
    v_mul_f32 v6, s36, v6
    v_mul_f32 v7, s36, v7
    v_cvt_pk_bf16_f32 v6, v6, v7
    v_accvgpr_write_b32 a178, v6
    v_lshlrev_b32 v8, 16, v67
    v_and_b32 v9, 0xffff0000, v67
    v_mul_f32 v8, s36, v8
    v_mul_f32 v9, s36, v9
    v_cvt_pk_bf16_f32 v8, v8, v9
    v_accvgpr_write_b32 a179, v8
    v_lshlrev_b32 v2, 16, v68
    v_and_b32 v3, 0xffff0000, v68
    v_mul_f32 v2, s36, v2
    v_mul_f32 v3, s36, v3
    v_cvt_pk_bf16_f32 v2, v2, v3
    v_accvgpr_write_b32 a180, v2
    v_lshlrev_b32 v4, 16, v69
    v_and_b32 v5, 0xffff0000, v69
    v_mul_f32 v4, s36, v4
    v_mul_f32 v5, s36, v5
    v_cvt_pk_bf16_f32 v4, v4, v5
    v_accvgpr_write_b32 a181, v4
    v_lshlrev_b32 v6, 16, v70
    v_and_b32 v7, 0xffff0000, v70
    v_mul_f32 v6, s36, v6
    v_mul_f32 v7, s36, v7
    v_cvt_pk_bf16_f32 v6, v6, v7
    v_accvgpr_write_b32 a182, v6
    v_lshlrev_b32 v8, 16, v71
    v_and_b32 v9, 0xffff0000, v71
    v_mul_f32 v8, s36, v8
    v_mul_f32 v9, s36, v9
    v_cvt_pk_bf16_f32 v8, v8, v9
    v_accvgpr_write_b32 a183, v8
    v_lshlrev_b32 v2, 16, v72
    v_and_b32 v3, 0xffff0000, v72
    v_mul_f32 v2, s36, v2
    v_mul_f32 v3, s36, v3
    v_cvt_pk_bf16_f32 v2, v2, v3
    v_accvgpr_write_b32 a184, v2
    v_lshlrev_b32 v4, 16, v73
    v_and_b32 v5, 0xffff0000, v73
    v_mul_f32 v4, s36, v4
    v_mul_f32 v5, s36, v5
    v_cvt_pk_bf16_f32 v4, v4, v5
    v_accvgpr_write_b32 a185, v4
    v_lshlrev_b32 v6, 16, v74
    v_and_b32 v7, 0xffff0000, v74
    v_mul_f32 v6, s36, v6
    v_mul_f32 v7, s36, v7
    v_cvt_pk_bf16_f32 v6, v6, v7
    v_accvgpr_write_b32 a186, v6
    v_lshlrev_b32 v8, 16, v75
    v_and_b32 v9, 0xffff0000, v75
    v_mul_f32 v8, s36, v8
    v_mul_f32 v9, s36, v9
    v_cvt_pk_bf16_f32 v8, v8, v9
    v_accvgpr_write_b32 a187, v8
    v_lshlrev_b32 v2, 16, v76
    v_and_b32 v3, 0xffff0000, v76
    v_mul_f32 v2, s36, v2
    v_mul_f32 v3, s36, v3
    v_cvt_pk_bf16_f32 v2, v2, v3
    v_accvgpr_write_b32 a188, v2
    v_lshlrev_b32 v4, 16, v77
    v_and_b32 v5, 0xffff0000, v77
    v_mul_f32 v4, s36, v4
    v_mul_f32 v5, s36, v5
    v_cvt_pk_bf16_f32 v4, v4, v5
    v_accvgpr_write_b32 a189, v4
    v_lshlrev_b32 v6, 16, v78
    v_and_b32 v7, 0xffff0000, v78
    v_mul_f32 v6, s36, v6
    v_mul_f32 v7, s36, v7
    v_cvt_pk_bf16_f32 v6, v6, v7
    v_accvgpr_write_b32 a190, v6
    v_lshlrev_b32 v8, 16, v79
    v_and_b32 v9, 0xffff0000, v79
    v_mul_f32 v8, s36, v8
    v_mul_f32 v9, s36, v9
    v_cvt_pk_bf16_f32 v8, v8, v9
    v_accvgpr_write_b32 a191, v8
    s_waitcnt vmcnt(8)
    s_barrier
    ds_read_b128 v[80:83], v144 offset:0
    ds_read_b128 v[84:87], v145 offset:0
    ds_read_b128 v[88:91], v146 offset:0
    ds_read_b128 v[92:95], v147 offset:0
    ds_read_b128 v[96:99], v148 offset:0
    ds_read_b128 v[100:103], v149 offset:0
    ds_read_b128 v[104:107], v150 offset:0
    ds_read_b128 v[108:111], v151 offset:0
    s_waitcnt lgkmcnt(7)
    v_mfma_f32_32x32x16_bf16 v[16:31], v[80:83], a[128:131], 0
    v_mfma_f32_32x32x16_bf16 v[32:47], v[80:83], a[160:163], 0
    s_waitcnt lgkmcnt(6)
    v_mfma_f32_32x32x16_bf16 v[16:31], v[84:87], a[132:135], v[16:31]
    v_mfma_f32_32x32x16_bf16 v[32:47], v[84:87], a[164:167], v[32:47]
    s_waitcnt lgkmcnt(5)
    v_mfma_f32_32x32x16_bf16 v[16:31], v[88:91], a[136:139], v[16:31]
    v_mfma_f32_32x32x16_bf16 v[32:47], v[88:91], a[168:171], v[32:47]
    s_waitcnt lgkmcnt(4)
    v_mfma_f32_32x32x16_bf16 v[16:31], v[92:95], a[140:143], v[16:31]
    v_mfma_f32_32x32x16_bf16 v[32:47], v[92:95], a[172:175], v[32:47]
    s_waitcnt lgkmcnt(3)
    v_mfma_f32_32x32x16_bf16 v[16:31], v[96:99], a[144:147], v[16:31]
    v_mfma_f32_32x32x16_bf16 v[32:47], v[96:99], a[176:179], v[32:47]
    s_waitcnt lgkmcnt(2)
    v_mfma_f32_32x32x16_bf16 v[16:31], v[100:103], a[148:151], v[16:31]
    v_mfma_f32_32x32x16_bf16 v[32:47], v[100:103], a[180:183], v[32:47]
    s_waitcnt lgkmcnt(1)
    v_mfma_f32_32x32x16_bf16 v[16:31], v[104:107], a[152:155], v[16:31]
    v_mfma_f32_32x32x16_bf16 v[32:47], v[104:107], a[184:187], v[32:47]
    s_waitcnt lgkmcnt(0)
    v_mfma_f32_32x32x16_bf16 v[16:31], v[108:111], a[156:159], v[16:31]
    v_mfma_f32_32x32x16_bf16 v[32:47], v[108:111], a[188:191], v[32:47]
    ds_read_b128 v[80:83], v144 offset:16384
    ds_read_b128 v[84:87], v145 offset:16384
    ds_read_b128 v[88:91], v146 offset:16384
    ds_read_b128 v[92:95], v147 offset:16384
    ds_read_b128 v[96:99], v148 offset:16384
    ds_read_b128 v[100:103], v149 offset:16384
    ds_read_b128 v[104:107], v150 offset:16384
    ds_read_b128 v[108:111], v151 offset:16384
    s_nop 2
    v_max3_f32 v171, v16, v17, v18
    v_max3_f32 v172, v19, v20, v21
    v_max3_f32 v171, v171, v22, v23
    v_max3_f32 v172, v172, v24, v25
    v_max3_f32 v171, v171, v26, v27
    v_max3_f32 v172, v172, v28, v29
    v_max3_f32 v171, v171, v30, v31
    v_max_f32 v171, v171, v172
    v_mov_b32 v172, v171
    s_nop 1
    v_permlane32_swap_b32 v171, v172
    v_max_f32 v171, v171, v172
    v_sub_f32 v16, v16, v171
    v_sub_f32 v17, v17, v171
    v_sub_f32 v18, v18, v171
    v_sub_f32 v19, v19, v171
    v_sub_f32 v20, v20, v171
    v_sub_f32 v21, v21, v171
    v_sub_f32 v22, v22, v171
    v_sub_f32 v23, v23, v171
    v_sub_f32 v24, v24, v171
    v_sub_f32 v25, v25, v171
    v_sub_f32 v26, v26, v171
    v_sub_f32 v27, v27, v171
    v_sub_f32 v28, v28, v171
    v_sub_f32 v29, v29, v171
    v_sub_f32 v30, v30, v171
    v_sub_f32 v31, v31, v171
    v_sub_f32 v192, 0, v171
    v_sub_f32 v193, 0, v171
    v_sub_f32 v194, 0, v171
    v_sub_f32 v195, 0, v171
    v_sub_f32 v196, 0, v171
    v_sub_f32 v197, 0, v171
    v_sub_f32 v198, 0, v171
    v_sub_f32 v199, 0, v171
    v_sub_f32 v200, 0, v171
    v_sub_f32 v201, 0, v171
    v_sub_f32 v202, 0, v171
    v_sub_f32 v203, 0, v171
    v_sub_f32 v204, 0, v171
    v_sub_f32 v205, 0, v171
    v_sub_f32 v206, 0, v171
    v_sub_f32 v207, 0, v171
    v_max3_f32 v176, v32, v33, v34
    v_max3_f32 v177, v35, v36, v37
    v_max3_f32 v176, v176, v38, v39
    v_max3_f32 v177, v177, v40, v41
    v_max3_f32 v176, v176, v42, v43
    v_max3_f32 v177, v177, v44, v45
    v_max3_f32 v176, v176, v46, v47
    v_max_f32 v176, v176, v177
    v_mov_b32 v177, v176
    s_nop 1
    v_permlane32_swap_b32 v176, v177
    v_max_f32 v176, v176, v177
    v_sub_f32 v32, v32, v176
    v_sub_f32 v33, v33, v176
    v_sub_f32 v34, v34, v176
    v_sub_f32 v35, v35, v176
    v_sub_f32 v36, v36, v176
    v_sub_f32 v37, v37, v176
    v_sub_f32 v38, v38, v176
    v_sub_f32 v39, v39, v176
    v_sub_f32 v40, v40, v176
    v_sub_f32 v41, v41, v176
    v_sub_f32 v42, v42, v176
    v_sub_f32 v43, v43, v176
    v_sub_f32 v44, v44, v176
    v_sub_f32 v45, v45, v176
    v_sub_f32 v46, v46, v176
    v_sub_f32 v47, v47, v176
    v_sub_f32 v208, 0, v176
    v_sub_f32 v209, 0, v176
    v_sub_f32 v210, 0, v176
    v_sub_f32 v211, 0, v176
    v_sub_f32 v212, 0, v176
    v_sub_f32 v213, 0, v176
    v_sub_f32 v214, 0, v176
    v_sub_f32 v215, 0, v176
    v_sub_f32 v216, 0, v176
    v_sub_f32 v217, 0, v176
    v_sub_f32 v218, 0, v176
    v_sub_f32 v219, 0, v176
    v_sub_f32 v220, 0, v176
    v_sub_f32 v221, 0, v176
    v_sub_f32 v222, 0, v176
    v_sub_f32 v223, 0, v176
    v_exp_f32 v16, v16
    v_exp_f32 v17, v17
    v_exp_f32 v18, v18
    v_exp_f32 v19, v19
    v_add_f32 v168, v168, v16
    v_add_f32 v169, v169, v17
    v_cvt_pk_bf16_f32 v16, v16, v17
    v_exp_f32 v20, v20
    v_exp_f32 v21, v21
    v_add_f32 v168, v168, v18
    v_add_f32 v169, v169, v19
    v_cvt_pk_bf16_f32 v17, v18, v19
    v_exp_f32 v22, v22
    v_exp_f32 v23, v23
    v_add_f32 v168, v168, v20
    v_add_f32 v169, v169, v21
    v_cvt_pk_bf16_f32 v18, v20, v21
    v_exp_f32 v24, v24
    v_exp_f32 v25, v25
    v_add_f32 v168, v168, v22
    v_add_f32 v169, v169, v23
    v_cvt_pk_bf16_f32 v19, v22, v23
    v_exp_f32 v26, v26
    v_exp_f32 v27, v27
    v_add_f32 v168, v168, v24
    v_add_f32 v169, v169, v25
    v_cvt_pk_bf16_f32 v20, v24, v25
    v_exp_f32 v28, v28
    v_exp_f32 v29, v29
    v_add_f32 v168, v168, v26
    v_add_f32 v169, v169, v27
    v_cvt_pk_bf16_f32 v21, v26, v27
    v_exp_f32 v30, v30
    v_exp_f32 v31, v31
    v_add_f32 v168, v168, v28
    v_add_f32 v169, v169, v29
    v_cvt_pk_bf16_f32 v22, v28, v29
    v_add_f32 v168, v168, v30
    s_mov_b32 s42, 7
L_loop:
    s_waitcnt vmcnt(8)
    s_barrier
    s_waitcnt lgkmcnt(0)
    v_mfma_f32_32x32x16_bf16 v[48:63], v[80:83], a[128:131], v[192:207]
    ds_read_b64_tr_b16 v[112:113], v160 offset:8192
    v_add_f32 v169, v169, v31
    v_cvt_pk_bf16_f32 v23, v30, v31
    v_exp_f32 v32, v32
    v_mfma_f32_32x32x16_bf16 v[64:79], v[80:83], a[160:163], v[208:223]
    ds_read_b64_tr_b16 v[114:115], v160 offset:10240
    v_exp_f32 v33, v33
    v_exp_f32 v34, v34
    v_mfma_f32_32x32x16_bf16 v[48:63], v[84:87], a[132:135], v[48:63]
    ds_read_b64_tr_b16 v[116:117], v161 offset:8192
    v_exp_f32 v35, v35
    v_add_f32 v173, v173, v32
    v_add_f32 v174, v174, v33
    v_mfma_f32_32x32x16_bf16 v[64:79], v[84:87], a[164:167], v[64:79]
    ds_read_b64_tr_b16 v[118:119], v161 offset:10240
    v_cvt_pk_bf16_f32 v32, v32, v33
    v_exp_f32 v36, v36
    v_mfma_f32_32x32x16_bf16 v[48:63], v[88:91], a[136:139], v[48:63]
    ds_read_b64_tr_b16 v[120:121], v162 offset:8192
    v_exp_f32 v37, v37
    v_add_f32 v173, v173, v34
    v_add_f32 v174, v174, v35
    v_mfma_f32_32x32x16_bf16 v[64:79], v[88:91], a[168:171], v[64:79]
    ds_read_b64_tr_b16 v[122:123], v162 offset:10240
    v_cvt_pk_bf16_f32 v33, v34, v35
    v_exp_f32 v38, v38
    v_mfma_f32_32x32x16_bf16 v[48:63], v[92:95], a[140:143], v[48:63]
    ds_read_b64_tr_b16 v[124:125], v163 offset:8192
    v_exp_f32 v39, v39
    v_add_f32 v173, v173, v36
    v_add_f32 v174, v174, v37
    v_mfma_f32_32x32x16_bf16 v[64:79], v[92:95], a[172:175], v[64:79]
    ds_read_b64_tr_b16 v[126:127], v163 offset:10240
    v_cvt_pk_bf16_f32 v34, v36, v37
    v_exp_f32 v40, v40
    v_mfma_f32_32x32x16_bf16 v[48:63], v[96:99], a[144:147], v[48:63]
    ds_read_b64_tr_b16 v[128:129], v160 offset:12288
    v_exp_f32 v41, v41
    v_add_f32 v173, v173, v38
    v_add_f32 v174, v174, v39
    v_mfma_f32_32x32x16_bf16 v[64:79], v[96:99], a[176:179], v[64:79]
    ds_read_b64_tr_b16 v[130:131], v160 offset:14336
    v_cvt_pk_bf16_f32 v35, v38, v39
    v_exp_f32 v42, v42
    v_mfma_f32_32x32x16_bf16 v[48:63], v[100:103], a[148:151], v[48:63]
    ds_read_b64_tr_b16 v[132:133], v161 offset:12288
    v_exp_f32 v43, v43
    v_add_f32 v173, v173, v40
    v_add_f32 v174, v174, v41
    v_mfma_f32_32x32x16_bf16 v[64:79], v[100:103], a[180:183], v[64:79]
    ds_read_b64_tr_b16 v[134:135], v161 offset:14336
    v_cvt_pk_bf16_f32 v36, v40, v41
    v_exp_f32 v44, v44
    v_mfma_f32_32x32x16_bf16 v[48:63], v[104:107], a[152:155], v[48:63]
    ds_read_b64_tr_b16 v[136:137], v162 offset:12288
    v_exp_f32 v45, v45
    v_add_f32 v173, v173, v42
    v_add_f32 v174, v174, v43
    v_mfma_f32_32x32x16_bf16 v[64:79], v[104:107], a[184:187], v[64:79]
    ds_read_b64_tr_b16 v[138:139], v162 offset:14336
    v_cvt_pk_bf16_f32 v37, v42, v43
    v_exp_f32 v46, v46
    v_mfma_f32_32x32x16_bf16 v[48:63], v[108:111], a[156:159], v[48:63]
    ds_read_b64_tr_b16 v[140:141], v163 offset:12288
    v_exp_f32 v47, v47
    v_add_f32 v173, v173, v44
    v_add_f32 v174, v174, v45
    v_mfma_f32_32x32x16_bf16 v[64:79], v[108:111], a[188:191], v[64:79]
    s_waitcnt lgkmcnt(14)
    ds_read_b64_tr_b16 v[142:143], v163 offset:14336
    v_cvt_pk_bf16_f32 v38, v44, v45
    v_add_f32 v173, v173, v46
    v_add_f32 v174, v174, v47
    v_cvt_pk_bf16_f32 v39, v46, v47
    s_add_u32 m0, s44, 98304
    s_nop 0
    buffer_load_dwordx4 v184, s[12:15], s38 offen lds
    buffer_load_dwordx4 v185, s[12:15], s38 offen offset:1024 lds
    s_add_u32 m0, s44, 106496
    s_nop 0
    buffer_load_dwordx4 v186, s[16:19], s38 offen lds
    buffer_load_dwordx4 v186, s[16:19], s38 offen offset:1024 lds
    s_add_u32 s38, s38, 8192
    s_cmp_eq_u32 s39, 0
    s_cbranch_scc1 L_ap7
    s_call_b64 s[40:41], L_apply
L_ap7:
    s_waitcnt lgkmcnt(8)
    v_mfma_f32_32x32x16_bf16 a[0:15], v[112:115], v[16:19], a[0:15]
    ds_read_b128 v[80:83], v144 offset:32768
    v_max3_f32 v171, v48, v49, v50
    v_max3_f32 v172, v51, v52, v53
    v_max3_f32 v171, v171, v54, v55
    v_max3_f32 v172, v172, v56, v57
    v_max3_f32 v171, v171, v58, v59
    v_mfma_f32_32x32x16_bf16 a[64:79], v[112:115], v[32:35], a[64:79]
    ds_read_b128 v[84:87], v145 offset:32768
    v_max3_f32 v172, v172, v60, v61
    v_max3_f32 v171, v171, v62, v63
    v_max_f32 v171, v171, v172
    v_max3_f32 v176, v64, v65, v66
    v_max3_f32 v177, v67, v68, v69
    v_mfma_f32_32x32x16_bf16 a[16:31], v[116:119], v[16:19], a[16:31]
    ds_read_b128 v[88:91], v146 offset:32768
    v_max3_f32 v176, v176, v70, v71
    v_max3_f32 v177, v177, v72, v73
    v_max3_f32 v176, v176, v74, v75
    v_max3_f32 v177, v177, v76, v77
    v_max3_f32 v176, v176, v78, v79
    v_mfma_f32_32x32x16_bf16 a[80:95], v[116:119], v[32:35], a[80:95]
    ds_read_b128 v[92:95], v147 offset:32768
    v_max_f32 v176, v176, v177
    v_cmp_lt_f32 vcc, s37, v171
    s_cbranch_vccz L_sk5
    s_call_b64 s[40:41], L_rare01
L_sk5:
    v_cmp_lt_f32 vcc, s37, v176
    s_cbranch_vccz L_sk6
    s_call_b64 s[40:41], L_rare11
L_sk6:
    v_mfma_f32_32x32x16_bf16 a[32:47], v[120:123], v[16:19], a[32:47]
    ds_read_b128 v[96:99], v148 offset:32768
    v_exp_f32 v48, v48
    v_exp_f32 v49, v49
    v_mfma_f32_32x32x16_bf16 a[96:111], v[120:123], v[32:35], a[96:111]
    ds_read_b128 v[100:103], v149 offset:32768
    v_exp_f32 v50, v50
    v_exp_f32 v51, v51
    v_add_f32 v168, v168, v48
    v_mfma_f32_32x32x16_bf16 a[48:63], v[124:127], v[16:19], a[48:63]
    ds_read_b128 v[104:107], v150 offset:32768
    v_add_f32 v169, v169, v49
    v_cvt_pk_bf16_f32 v48, v48, v49
    v_exp_f32 v52, v52
    v_mfma_f32_32x32x16_bf16 a[112:127], v[124:127], v[32:35], a[112:127]
    s_waitcnt lgkmcnt(14)
    ds_read_b128 v[108:111], v151 offset:32768
    v_exp_f32 v53, v53
    v_add_f32 v168, v168, v50
    v_add_f32 v169, v169, v51
    v_cvt_pk_bf16_f32 v49, v50, v51
    s_waitcnt lgkmcnt(8)
    v_mfma_f32_32x32x16_bf16 a[0:15], v[128:131], v[20:23], a[0:15]
    v_exp_f32 v54, v54
    v_exp_f32 v55, v55
    v_add_f32 v168, v168, v52
    v_add_f32 v169, v169, v53
    v_mfma_f32_32x32x16_bf16 a[64:79], v[128:131], v[36:39], a[64:79]
    s_add_u32 m0, s44, 114688
    s_nop 0
    buffer_load_dwordx4 v184, s[12:15], s38 offen lds
    buffer_load_dwordx4 v185, s[12:15], s38 offen offset:1024 lds
    v_mfma_f32_32x32x16_bf16 a[16:31], v[132:135], v[20:23], a[16:31]
    v_cvt_pk_bf16_f32 v50, v52, v53
    v_exp_f32 v56, v56
    v_exp_f32 v57, v57
    v_add_f32 v168, v168, v54
    v_mfma_f32_32x32x16_bf16 a[80:95], v[132:135], v[36:39], a[80:95]
    v_add_f32 v169, v169, v55
    v_cvt_pk_bf16_f32 v51, v54, v55
    v_exp_f32 v58, v58
    v_exp_f32 v59, v59
    v_mfma_f32_32x32x16_bf16 a[32:47], v[136:139], v[20:23], a[32:47]
    v_add_f32 v168, v168, v56
    v_add_f32 v169, v169, v57
    v_cvt_pk_bf16_f32 v52, v56, v57
    v_exp_f32 v60, v60
    v_mfma_f32_32x32x16_bf16 a[96:111], v[136:139], v[36:39], a[96:111]
    s_add_u32 m0, s44, 122880
    s_nop 0
    buffer_load_dwordx4 v186, s[16:19], s38 offen lds
    buffer_load_dwordx4 v186, s[16:19], s38 offen offset:1024 lds
    s_add_u32 s38, s38, 8192
    v_mfma_f32_32x32x16_bf16 a[48:63], v[140:143], v[20:23], a[48:63]
    v_exp_f32 v61, v61
    v_add_f32 v168, v168, v58
    v_add_f32 v169, v169, v59
    v_cvt_pk_bf16_f32 v53, v58, v59
    v_mfma_f32_32x32x16_bf16 a[112:127], v[140:143], v[36:39], a[112:127]
    v_exp_f32 v62, v62
    v_exp_f32 v63, v63
    v_add_f32 v168, v168, v60
    v_add_f32 v169, v169, v61
    v_cvt_pk_bf16_f32 v54, v60, v61
    v_add_f32 v168, v168, v62
    s_waitcnt lgkmcnt(0)
    v_mfma_f32_32x32x16_bf16 v[16:31], v[80:83], a[128:131], v[192:207]
    ds_read_b64_tr_b16 v[112:113], v160 offset:24576
    v_add_f32 v169, v169, v63
    v_cvt_pk_bf16_f32 v55, v62, v63
    v_exp_f32 v64, v64
    v_mfma_f32_32x32x16_bf16 v[32:47], v[80:83], a[160:163], v[208:223]
    ds_read_b64_tr_b16 v[114:115], v160 offset:26624
    v_exp_f32 v65, v65
    v_exp_f32 v66, v66
    v_mfma_f32_32x32x16_bf16 v[16:31], v[84:87], a[132:135], v[16:31]
    ds_read_b64_tr_b16 v[116:117], v161 offset:24576
    v_exp_f32 v67, v67
    v_add_f32 v173, v173, v64
    v_add_f32 v174, v174, v65
    v_mfma_f32_32x32x16_bf16 v[32:47], v[84:87], a[164:167], v[32:47]
    ds_read_b64_tr_b16 v[118:119], v161 offset:26624
    v_cvt_pk_bf16_f32 v64, v64, v65
    v_exp_f32 v68, v68
    v_mfma_f32_32x32x16_bf16 v[16:31], v[88:91], a[136:139], v[16:31]
    ds_read_b64_tr_b16 v[120:121], v162 offset:24576
    v_exp_f32 v69, v69
    v_add_f32 v173, v173, v66
    v_add_f32 v174, v174, v67
    v_mfma_f32_32x32x16_bf16 v[32:47], v[88:91], a[168:171], v[32:47]
    ds_read_b64_tr_b16 v[122:123], v162 offset:26624
    v_cvt_pk_bf16_f32 v65, v66, v67
    v_exp_f32 v70, v70
    v_mfma_f32_32x32x16_bf16 v[16:31], v[92:95], a[140:143], v[16:31]
    ds_read_b64_tr_b16 v[124:125], v163 offset:24576
    v_exp_f32 v71, v71
    v_add_f32 v173, v173, v68
    v_add_f32 v174, v174, v69
    v_mfma_f32_32x32x16_bf16 v[32:47], v[92:95], a[172:175], v[32:47]
    ds_read_b64_tr_b16 v[126:127], v163 offset:26624
    v_cvt_pk_bf16_f32 v66, v68, v69
    v_exp_f32 v72, v72
    v_mfma_f32_32x32x16_bf16 v[16:31], v[96:99], a[144:147], v[16:31]
    ds_read_b64_tr_b16 v[128:129], v160 offset:28672
    v_exp_f32 v73, v73
    v_add_f32 v173, v173, v70
    v_add_f32 v174, v174, v71
    v_mfma_f32_32x32x16_bf16 v[32:47], v[96:99], a[176:179], v[32:47]
    ds_read_b64_tr_b16 v[130:131], v160 offset:30720
    v_cvt_pk_bf16_f32 v67, v70, v71
    v_exp_f32 v74, v74
    v_mfma_f32_32x32x16_bf16 v[16:31], v[100:103], a[148:151], v[16:31]
    ds_read_b64_tr_b16 v[132:133], v161 offset:28672
    v_exp_f32 v75, v75
    v_add_f32 v173, v173, v72
    v_add_f32 v174, v174, v73
    v_mfma_f32_32x32x16_bf16 v[32:47], v[100:103], a[180:183], v[32:47]
    ds_read_b64_tr_b16 v[134:135], v161 offset:30720
    v_cvt_pk_bf16_f32 v68, v72, v73
    v_exp_f32 v76, v76
    v_mfma_f32_32x32x16_bf16 v[16:31], v[104:107], a[152:155], v[16:31]
    ds_read_b64_tr_b16 v[136:137], v162 offset:28672
    v_exp_f32 v77, v77
    v_add_f32 v173, v173, v74
    v_add_f32 v174, v174, v75
    v_mfma_f32_32x32x16_bf16 v[32:47], v[104:107], a[184:187], v[32:47]
    ds_read_b64_tr_b16 v[138:139], v162 offset:30720
    v_cvt_pk_bf16_f32 v69, v74, v75
    v_exp_f32 v78, v78
    v_mfma_f32_32x32x16_bf16 v[16:31], v[108:111], a[156:159], v[16:31]
    ds_read_b64_tr_b16 v[140:141], v163 offset:28672
    v_exp_f32 v79, v79
    v_add_f32 v173, v173, v76
    v_add_f32 v174, v174, v77
    v_mfma_f32_32x32x16_bf16 v[32:47], v[108:111], a[188:191], v[32:47]
    s_waitcnt lgkmcnt(14)
    ds_read_b64_tr_b16 v[142:143], v163 offset:30720
    v_cvt_pk_bf16_f32 v70, v76, v77
    v_add_f32 v173, v173, v78
    v_add_f32 v174, v174, v79
    v_cvt_pk_bf16_f32 v71, v78, v79
    s_cmp_eq_u32 s39, 0
    s_cbranch_scc1 L_ap12
    s_call_b64 s[40:41], L_apply
L_ap12:
    s_waitcnt lgkmcnt(8)
    v_mfma_f32_32x32x16_bf16 a[0:15], v[112:115], v[48:51], a[0:15]
    ds_read_b128 v[80:83], v144 offset:49152
    v_max3_f32 v171, v16, v17, v18
    v_max3_f32 v172, v19, v20, v21
    v_max3_f32 v171, v171, v22, v23
    v_max3_f32 v172, v172, v24, v25
    v_max3_f32 v171, v171, v26, v27
    v_mfma_f32_32x32x16_bf16 a[64:79], v[112:115], v[64:67], a[64:79]
    ds_read_b128 v[84:87], v145 offset:49152
    v_max3_f32 v172, v172, v28, v29
    v_max3_f32 v171, v171, v30, v31
    v_max_f32 v171, v171, v172
    v_max3_f32 v176, v32, v33, v34
    v_max3_f32 v177, v35, v36, v37
    v_mfma_f32_32x32x16_bf16 a[16:31], v[116:119], v[48:51], a[16:31]
    ds_read_b128 v[88:91], v146 offset:49152
    v_max3_f32 v176, v176, v38, v39
    v_max3_f32 v177, v177, v40, v41
    v_max3_f32 v176, v176, v42, v43
    v_max3_f32 v177, v177, v44, v45
    v_max3_f32 v176, v176, v46, v47
    v_mfma_f32_32x32x16_bf16 a[80:95], v[116:119], v[64:67], a[80:95]
    ds_read_b128 v[92:95], v147 offset:49152
    v_max_f32 v176, v176, v177
    v_cmp_lt_f32 vcc, s37, v171
    s_cbranch_vccz L_sk10
    s_call_b64 s[40:41], L_rare00
L_sk10:
    v_cmp_lt_f32 vcc, s37, v176
    s_cbranch_vccz L_sk11
    s_call_b64 s[40:41], L_rare10
L_sk11:
    v_mfma_f32_32x32x16_bf16 a[32:47], v[120:123], v[48:51], a[32:47]
    ds_read_b128 v[96:99], v148 offset:49152
    v_exp_f32 v16, v16
    v_exp_f32 v17, v17
    v_mfma_f32_32x32x16_bf16 a[96:111], v[120:123], v[64:67], a[96:111]
    ds_read_b128 v[100:103], v149 offset:49152
    v_exp_f32 v18, v18
    v_exp_f32 v19, v19
    v_add_f32 v168, v168, v16
    v_mfma_f32_32x32x16_bf16 a[48:63], v[124:127], v[48:51], a[48:63]
    ds_read_b128 v[104:107], v150 offset:49152
    v_add_f32 v169, v169, v17
    v_cvt_pk_bf16_f32 v16, v16, v17
    v_exp_f32 v20, v20
    v_mfma_f32_32x32x16_bf16 a[112:127], v[124:127], v[64:67], a[112:127]
    s_waitcnt lgkmcnt(14)
    ds_read_b128 v[108:111], v151 offset:49152
    v_exp_f32 v21, v21
    v_add_f32 v168, v168, v18
    v_add_f32 v169, v169, v19
    v_cvt_pk_bf16_f32 v17, v18, v19
    s_waitcnt lgkmcnt(8)
    v_mfma_f32_32x32x16_bf16 a[0:15], v[128:131], v[52:55], a[0:15]
    v_exp_f32 v22, v22
    v_exp_f32 v23, v23
    v_add_f32 v168, v168, v20
    v_add_f32 v169, v169, v21
    v_mfma_f32_32x32x16_bf16 a[64:79], v[128:131], v[68:71], a[64:79]
    v_cvt_pk_bf16_f32 v18, v20, v21
    v_exp_f32 v24, v24
    v_exp_f32 v25, v25
    v_add_f32 v168, v168, v22
    v_mfma_f32_32x32x16_bf16 a[16:31], v[132:135], v[52:55], a[16:31]
    v_add_f32 v169, v169, v23
    v_cvt_pk_bf16_f32 v19, v22, v23
    v_exp_f32 v26, v26
    v_exp_f32 v27, v27
    v_mfma_f32_32x32x16_bf16 a[80:95], v[132:135], v[68:71], a[80:95]
    v_add_f32 v168, v168, v24
    v_add_f32 v169, v169, v25
    v_cvt_pk_bf16_f32 v20, v24, v25
    v_exp_f32 v28, v28
    v_mfma_f32_32x32x16_bf16 a[32:47], v[136:139], v[52:55], a[32:47]
    v_exp_f32 v29, v29
    v_add_f32 v168, v168, v26
    v_add_f32 v169, v169, v27
    v_cvt_pk_bf16_f32 v21, v26, v27
    v_mfma_f32_32x32x16_bf16 a[96:111], v[136:139], v[68:71], a[96:111]
    v_exp_f32 v30, v30
    v_exp_f32 v31, v31
    v_add_f32 v168, v168, v28
    v_add_f32 v169, v169, v29
    v_mfma_f32_32x32x16_bf16 a[48:63], v[140:143], v[52:55], a[48:63]
    v_cvt_pk_bf16_f32 v22, v28, v29
    v_add_f32 v168, v168, v30
    v_mfma_f32_32x32x16_bf16 a[112:127], v[140:143], v[68:71], a[112:127]
    s_waitcnt vmcnt(8)
    s_barrier
    s_waitcnt lgkmcnt(0)
    v_mfma_f32_32x32x16_bf16 v[48:63], v[80:83], a[128:131], v[192:207]
    ds_read_b64_tr_b16 v[112:113], v160 offset:40960
    v_add_f32 v169, v169, v31
    v_cvt_pk_bf16_f32 v23, v30, v31
    v_exp_f32 v32, v32
    v_mfma_f32_32x32x16_bf16 v[64:79], v[80:83], a[160:163], v[208:223]
    ds_read_b64_tr_b16 v[114:115], v160 offset:43008
    v_exp_f32 v33, v33
    v_exp_f32 v34, v34
    v_mfma_f32_32x32x16_bf16 v[48:63], v[84:87], a[132:135], v[48:63]
    ds_read_b64_tr_b16 v[116:117], v161 offset:40960
    v_exp_f32 v35, v35
    v_add_f32 v173, v173, v32
    v_add_f32 v174, v174, v33
    v_mfma_f32_32x32x16_bf16 v[64:79], v[84:87], a[164:167], v[64:79]
    ds_read_b64_tr_b16 v[118:119], v161 offset:43008
    v_cvt_pk_bf16_f32 v32, v32, v33
    v_exp_f32 v36, v36
    v_mfma_f32_32x32x16_bf16 v[48:63], v[88:91], a[136:139], v[48:63]
    ds_read_b64_tr_b16 v[120:121], v162 offset:40960
    v_exp_f32 v37, v37
    v_add_f32 v173, v173, v34
    v_add_f32 v174, v174, v35
    v_mfma_f32_32x32x16_bf16 v[64:79], v[88:91], a[168:171], v[64:79]
    ds_read_b64_tr_b16 v[122:123], v162 offset:43008
    v_cvt_pk_bf16_f32 v33, v34, v35
    v_exp_f32 v38, v38
    v_mfma_f32_32x32x16_bf16 v[48:63], v[92:95], a[140:143], v[48:63]
    ds_read_b64_tr_b16 v[124:125], v163 offset:40960
    v_exp_f32 v39, v39
    v_add_f32 v173, v173, v36
    v_add_f32 v174, v174, v37
    v_mfma_f32_32x32x16_bf16 v[64:79], v[92:95], a[172:175], v[64:79]
    ds_read_b64_tr_b16 v[126:127], v163 offset:43008
    v_cvt_pk_bf16_f32 v34, v36, v37
    v_exp_f32 v40, v40
    v_mfma_f32_32x32x16_bf16 v[48:63], v[96:99], a[144:147], v[48:63]
    ds_read_b64_tr_b16 v[128:129], v160 offset:45056
    v_exp_f32 v41, v41
    v_add_f32 v173, v173, v38
    v_add_f32 v174, v174, v39
    v_mfma_f32_32x32x16_bf16 v[64:79], v[96:99], a[176:179], v[64:79]
    ds_read_b64_tr_b16 v[130:131], v160 offset:47104
    v_cvt_pk_bf16_f32 v35, v38, v39
    v_exp_f32 v42, v42
    v_mfma_f32_32x32x16_bf16 v[48:63], v[100:103], a[148:151], v[48:63]
    ds_read_b64_tr_b16 v[132:133], v161 offset:45056
    v_exp_f32 v43, v43
    v_add_f32 v173, v173, v40
    v_add_f32 v174, v174, v41
    v_mfma_f32_32x32x16_bf16 v[64:79], v[100:103], a[180:183], v[64:79]
    ds_read_b64_tr_b16 v[134:135], v161 offset:47104
    v_cvt_pk_bf16_f32 v36, v40, v41
    v_exp_f32 v44, v44
    v_mfma_f32_32x32x16_bf16 v[48:63], v[104:107], a[152:155], v[48:63]
    ds_read_b64_tr_b16 v[136:137], v162 offset:45056
    v_exp_f32 v45, v45
    v_add_f32 v173, v173, v42
    v_add_f32 v174, v174, v43
    v_mfma_f32_32x32x16_bf16 v[64:79], v[104:107], a[184:187], v[64:79]
    ds_read_b64_tr_b16 v[138:139], v162 offset:47104
    v_cvt_pk_bf16_f32 v37, v42, v43
    v_exp_f32 v46, v46
    v_mfma_f32_32x32x16_bf16 v[48:63], v[108:111], a[156:159], v[48:63]
    ds_read_b64_tr_b16 v[140:141], v163 offset:45056
    v_exp_f32 v47, v47
    v_add_f32 v173, v173, v44
    v_add_f32 v174, v174, v45
    v_mfma_f32_32x32x16_bf16 v[64:79], v[108:111], a[188:191], v[64:79]
    s_waitcnt lgkmcnt(14)
    ds_read_b64_tr_b16 v[142:143], v163 offset:47104
    v_cvt_pk_bf16_f32 v38, v44, v45
    v_add_f32 v173, v173, v46
    v_add_f32 v174, v174, v47
    v_cvt_pk_bf16_f32 v39, v46, v47
    s_add_u32 m0, s44, 0
    s_nop 0
    buffer_load_dwordx4 v184, s[12:15], s38 offen lds
    buffer_load_dwordx4 v185, s[12:15], s38 offen offset:1024 lds
    s_add_u32 m0, s44, 8192
    s_nop 0
    buffer_load_dwordx4 v186, s[16:19], s38 offen lds
    buffer_load_dwordx4 v186, s[16:19], s38 offen offset:1024 lds
    s_add_u32 s38, s38, 8192
    s_cmp_eq_u32 s39, 0
    s_cbranch_scc1 L_ap17
    s_call_b64 s[40:41], L_apply
L_ap17:
    s_waitcnt lgkmcnt(8)
    v_mfma_f32_32x32x16_bf16 a[0:15], v[112:115], v[16:19], a[0:15]
    ds_read_b128 v[80:83], v152 offset:0
    v_max3_f32 v171, v48, v49, v50
    v_max3_f32 v172, v51, v52, v53
    v_max3_f32 v171, v171, v54, v55
    v_max3_f32 v172, v172, v56, v57
    v_max3_f32 v171, v171, v58, v59
    v_mfma_f32_32x32x16_bf16 a[64:79], v[112:115], v[32:35], a[64:79]
    ds_read_b128 v[84:87], v153 offset:0
    v_max3_f32 v172, v172, v60, v61
    v_max3_f32 v171, v171, v62, v63
    v_max_f32 v171, v171, v172
    v_max3_f32 v176, v64, v65, v66
    v_max3_f32 v177, v67, v68, v69
    v_mfma_f32_32x32x16_bf16 a[16:31], v[116:119], v[16:19], a[16:31]
    ds_read_b128 v[88:91], v154 offset:0
    v_max3_f32 v176, v176, v70, v71
    v_max3_f32 v177, v177, v72, v73
    v_max3_f32 v176, v176, v74, v75
    v_max3_f32 v177, v177, v76, v77
    v_max3_f32 v176, v176, v78, v79
    v_mfma_f32_32x32x16_bf16 a[80:95], v[116:119], v[32:35], a[80:95]
    ds_read_b128 v[92:95], v155 offset:0
    v_max_f32 v176, v176, v177
    v_cmp_lt_f32 vcc, s37, v171
    s_cbranch_vccz L_sk15
    s_call_b64 s[40:41], L_rare01
L_sk15:
    v_cmp_lt_f32 vcc, s37, v176
    s_cbranch_vccz L_sk16
    s_call_b64 s[40:41], L_rare11
L_sk16:
    v_mfma_f32_32x32x16_bf16 a[32:47], v[120:123], v[16:19], a[32:47]
    ds_read_b128 v[96:99], v156 offset:0
    v_exp_f32 v48, v48
    v_exp_f32 v49, v49
    v_mfma_f32_32x32x16_bf16 a[96:111], v[120:123], v[32:35], a[96:111]
    ds_read_b128 v[100:103], v157 offset:0
    v_exp_f32 v50, v50
    v_exp_f32 v51, v51
    v_add_f32 v168, v168, v48
    v_mfma_f32_32x32x16_bf16 a[48:63], v[124:127], v[16:19], a[48:63]
    ds_read_b128 v[104:107], v158 offset:0
    v_add_f32 v169, v169, v49
    v_cvt_pk_bf16_f32 v48, v48, v49
    v_exp_f32 v52, v52
    v_mfma_f32_32x32x16_bf16 a[112:127], v[124:127], v[32:35], a[112:127]
    s_waitcnt lgkmcnt(14)
    ds_read_b128 v[108:111], v159 offset:0
    v_exp_f32 v53, v53
    v_add_f32 v168, v168, v50
    v_add_f32 v169, v169, v51
    v_cvt_pk_bf16_f32 v49, v50, v51
    s_waitcnt lgkmcnt(8)
    v_mfma_f32_32x32x16_bf16 a[0:15], v[128:131], v[20:23], a[0:15]
    v_exp_f32 v54, v54
    v_exp_f32 v55, v55
    v_add_f32 v168, v168, v52
    v_add_f32 v169, v169, v53
    v_mfma_f32_32x32x16_bf16 a[64:79], v[128:131], v[36:39], a[64:79]
    s_add_u32 m0, s44, 16384
    s_nop 0
    buffer_load_dwordx4 v184, s[12:15], s38 offen lds
    buffer_load_dwordx4 v185, s[12:15], s38 offen offset:1024 lds
    v_mfma_f32_32x32x16_bf16 a[16:31], v[132:135], v[20:23], a[16:31]
    v_cvt_pk_bf16_f32 v50, v52, v53
    v_exp_f32 v56, v56
    v_exp_f32 v57, v57
    v_add_f32 v168, v168, v54
    v_mfma_f32_32x32x16_bf16 a[80:95], v[132:135], v[36:39], a[80:95]
    v_add_f32 v169, v169, v55
    v_cvt_pk_bf16_f32 v51, v54, v55
    v_exp_f32 v58, v58
    v_exp_f32 v59, v59
    v_mfma_f32_32x32x16_bf16 a[32:47], v[136:139], v[20:23], a[32:47]
    v_add_f32 v168, v168, v56
    v_add_f32 v169, v169, v57
    v_cvt_pk_bf16_f32 v52, v56, v57
    v_exp_f32 v60, v60
    v_mfma_f32_32x32x16_bf16 a[96:111], v[136:139], v[36:39], a[96:111]
    s_add_u32 m0, s44, 24576
    s_nop 0
    buffer_load_dwordx4 v186, s[16:19], s38 offen lds
    buffer_load_dwordx4 v186, s[16:19], s38 offen offset:1024 lds
    s_add_u32 s38, s38, 8192
    v_mfma_f32_32x32x16_bf16 a[48:63], v[140:143], v[20:23], a[48:63]
    v_exp_f32 v61, v61
    v_add_f32 v168, v168, v58
    v_add_f32 v169, v169, v59
    v_cvt_pk_bf16_f32 v53, v58, v59
    v_mfma_f32_32x32x16_bf16 a[112:127], v[140:143], v[36:39], a[112:127]
    v_exp_f32 v62, v62
    v_exp_f32 v63, v63
    v_add_f32 v168, v168, v60
    v_add_f32 v169, v169, v61
    v_cvt_pk_bf16_f32 v54, v60, v61
    v_add_f32 v168, v168, v62
    s_waitcnt lgkmcnt(0)
    v_mfma_f32_32x32x16_bf16 v[16:31], v[80:83], a[128:131], v[192:207]
    ds_read_b64_tr_b16 v[112:113], v160 offset:57344
    v_add_f32 v169, v169, v63
    v_cvt_pk_bf16_f32 v55, v62, v63
    v_exp_f32 v64, v64
    v_mfma_f32_32x32x16_bf16 v[32:47], v[80:83], a[160:163], v[208:223]
    ds_read_b64_tr_b16 v[114:115], v160 offset:59392
    v_exp_f32 v65, v65
    v_exp_f32 v66, v66
    v_mfma_f32_32x32x16_bf16 v[16:31], v[84:87], a[132:135], v[16:31]
    ds_read_b64_tr_b16 v[116:117], v161 offset:57344
    v_exp_f32 v67, v67
    v_add_f32 v173, v173, v64
    v_add_f32 v174, v174, v65
    v_mfma_f32_32x32x16_bf16 v[32:47], v[84:87], a[164:167], v[32:47]
    ds_read_b64_tr_b16 v[118:119], v161 offset:59392
    v_cvt_pk_bf16_f32 v64, v64, v65
    v_exp_f32 v68, v68
    v_mfma_f32_32x32x16_bf16 v[16:31], v[88:91], a[136:139], v[16:31]
    ds_read_b64_tr_b16 v[120:121], v162 offset:57344
    v_exp_f32 v69, v69
    v_add_f32 v173, v173, v66
    v_add_f32 v174, v174, v67
    v_mfma_f32_32x32x16_bf16 v[32:47], v[88:91], a[168:171], v[32:47]
    ds_read_b64_tr_b16 v[122:123], v162 offset:59392
    v_cvt_pk_bf16_f32 v65, v66, v67
    v_exp_f32 v70, v70
    v_mfma_f32_32x32x16_bf16 v[16:31], v[92:95], a[140:143], v[16:31]
    ds_read_b64_tr_b16 v[124:125], v163 offset:57344
    v_exp_f32 v71, v71
    v_add_f32 v173, v173, v68
    v_add_f32 v174, v174, v69
    v_mfma_f32_32x32x16_bf16 v[32:47], v[92:95], a[172:175], v[32:47]
    ds_read_b64_tr_b16 v[126:127], v163 offset:59392
    v_cvt_pk_bf16_f32 v66, v68, v69
    v_exp_f32 v72, v72
    v_mfma_f32_32x32x16_bf16 v[16:31], v[96:99], a[144:147], v[16:31]
    ds_read_b64_tr_b16 v[128:129], v160 offset:61440
    v_exp_f32 v73, v73
    v_add_f32 v173, v173, v70
    v_add_f32 v174, v174, v71
    v_mfma_f32_32x32x16_bf16 v[32:47], v[96:99], a[176:179], v[32:47]
    ds_read_b64_tr_b16 v[130:131], v160 offset:63488
    v_cvt_pk_bf16_f32 v67, v70, v71
    v_exp_f32 v74, v74
    v_mfma_f32_32x32x16_bf16 v[16:31], v[100:103], a[148:151], v[16:31]
    ds_read_b64_tr_b16 v[132:133], v161 offset:61440
    v_exp_f32 v75, v75
    v_add_f32 v173, v173, v72
    v_add_f32 v174, v174, v73
    v_mfma_f32_32x32x16_bf16 v[32:47], v[100:103], a[180:183], v[32:47]
    ds_read_b64_tr_b16 v[134:135], v161 offset:63488
    v_cvt_pk_bf16_f32 v68, v72, v73
    v_exp_f32 v76, v76
    v_mfma_f32_32x32x16_bf16 v[16:31], v[104:107], a[152:155], v[16:31]
    ds_read_b64_tr_b16 v[136:137], v162 offset:61440
    v_exp_f32 v77, v77
    v_add_f32 v173, v173, v74
    v_add_f32 v174, v174, v75
    v_mfma_f32_32x32x16_bf16 v[32:47], v[104:107], a[184:187], v[32:47]
    ds_read_b64_tr_b16 v[138:139], v162 offset:63488
    v_cvt_pk_bf16_f32 v69, v74, v75
    v_exp_f32 v78, v78
    v_mfma_f32_32x32x16_bf16 v[16:31], v[108:111], a[156:159], v[16:31]
    ds_read_b64_tr_b16 v[140:141], v163 offset:61440
    v_exp_f32 v79, v79
    v_add_f32 v173, v173, v76
    v_add_f32 v174, v174, v77
    v_mfma_f32_32x32x16_bf16 v[32:47], v[108:111], a[188:191], v[32:47]
    s_waitcnt lgkmcnt(14)
    ds_read_b64_tr_b16 v[142:143], v163 offset:63488
    v_cvt_pk_bf16_f32 v70, v76, v77
    v_add_f32 v173, v173, v78
    v_add_f32 v174, v174, v79
    v_cvt_pk_bf16_f32 v71, v78, v79
    s_cmp_eq_u32 s39, 0
    s_cbranch_scc1 L_ap22
    s_call_b64 s[40:41], L_apply
L_ap22:
    s_waitcnt lgkmcnt(8)
    v_mfma_f32_32x32x16_bf16 a[0:15], v[112:115], v[48:51], a[0:15]
    ds_read_b128 v[80:83], v152 offset:16384
    v_max3_f32 v171, v16, v17, v18
    v_max3_f32 v172, v19, v20, v21
    v_max3_f32 v171, v171, v22, v23
    v_max3_f32 v172, v172, v24, v25
    v_max3_f32 v171, v171, v26, v27
    v_mfma_f32_32x32x16_bf16 a[64:79], v[112:115], v[64:67], a[64:79]
    ds_read_b128 v[84:87], v153 offset:16384
    v_max3_f32 v172, v172, v28, v29
    v_max3_f32 v171, v171, v30, v31
    v_max_f32 v171, v171, v172
    v_max3_f32 v176, v32, v33, v34
    v_max3_f32 v177, v35, v36, v37
    v_mfma_f32_32x32x16_bf16 a[16:31], v[116:119], v[48:51], a[16:31]
    ds_read_b128 v[88:91], v154 offset:16384
    v_max3_f32 v176, v176, v38, v39
    v_max3_f32 v177, v177, v40, v41
    v_max3_f32 v176, v176, v42, v43
    v_max3_f32 v177, v177, v44, v45
    v_max3_f32 v176, v176, v46, v47
    v_mfma_f32_32x32x16_bf16 a[80:95], v[116:119], v[64:67], a[80:95]
    ds_read_b128 v[92:95], v155 offset:16384
    v_max_f32 v176, v176, v177
    v_cmp_lt_f32 vcc, s37, v171
    s_cbranch_vccz L_sk20
    s_call_b64 s[40:41], L_rare00
L_sk20:
    v_cmp_lt_f32 vcc, s37, v176
    s_cbranch_vccz L_sk21
    s_call_b64 s[40:41], L_rare10
L_sk21:
    v_mfma_f32_32x32x16_bf16 a[32:47], v[120:123], v[48:51], a[32:47]
    ds_read_b128 v[96:99], v156 offset:16384
    v_exp_f32 v16, v16
    v_exp_f32 v17, v17
    v_mfma_f32_32x32x16_bf16 a[96:111], v[120:123], v[64:67], a[96:111]
    ds_read_b128 v[100:103], v157 offset:16384
    v_exp_f32 v18, v18
    v_exp_f32 v19, v19
    v_add_f32 v168, v168, v16
    v_mfma_f32_32x32x16_bf16 a[48:63], v[124:127], v[48:51], a[48:63]
    ds_read_b128 v[104:107], v158 offset:16384
    v_add_f32 v169, v169, v17
    v_cvt_pk_bf16_f32 v16, v16, v17
    v_exp_f32 v20, v20
    v_mfma_f32_32x32x16_bf16 a[112:127], v[124:127], v[64:67], a[112:127]
    s_waitcnt lgkmcnt(14)
    ds_read_b128 v[108:111], v159 offset:16384
    v_exp_f32 v21, v21
    v_add_f32 v168, v168, v18
    v_add_f32 v169, v169, v19
    v_cvt_pk_bf16_f32 v17, v18, v19
    s_waitcnt lgkmcnt(8)
    v_mfma_f32_32x32x16_bf16 a[0:15], v[128:131], v[52:55], a[0:15]
    v_exp_f32 v22, v22
    v_exp_f32 v23, v23
    v_add_f32 v168, v168, v20
    v_add_f32 v169, v169, v21
    v_mfma_f32_32x32x16_bf16 a[64:79], v[128:131], v[68:71], a[64:79]
    v_cvt_pk_bf16_f32 v18, v20, v21
    v_exp_f32 v24, v24
    v_exp_f32 v25, v25
    v_add_f32 v168, v168, v22
    v_mfma_f32_32x32x16_bf16 a[16:31], v[132:135], v[52:55], a[16:31]
    v_add_f32 v169, v169, v23
    v_cvt_pk_bf16_f32 v19, v22, v23
    v_exp_f32 v26, v26
    v_exp_f32 v27, v27
    v_mfma_f32_32x32x16_bf16 a[80:95], v[132:135], v[68:71], a[80:95]
    v_add_f32 v168, v168, v24
    v_add_f32 v169, v169, v25
    v_cvt_pk_bf16_f32 v20, v24, v25
    v_exp_f32 v28, v28
    v_mfma_f32_32x32x16_bf16 a[32:47], v[136:139], v[52:55], a[32:47]
    v_exp_f32 v29, v29
    v_add_f32 v168, v168, v26
    v_add_f32 v169, v169, v27
    v_cvt_pk_bf16_f32 v21, v26, v27
    v_mfma_f32_32x32x16_bf16 a[96:111], v[136:139], v[68:71], a[96:111]
    v_exp_f32 v30, v30
    v_exp_f32 v31, v31
    v_add_f32 v168, v168, v28
    v_add_f32 v169, v169, v29
    v_mfma_f32_32x32x16_bf16 a[48:63], v[140:143], v[52:55], a[48:63]
    v_cvt_pk_bf16_f32 v22, v28, v29
    v_add_f32 v168, v168, v30
    v_mfma_f32_32x32x16_bf16 a[112:127], v[140:143], v[68:71], a[112:127]
    s_waitcnt vmcnt(8)
    s_barrier
    s_waitcnt lgkmcnt(0)
    v_mfma_f32_32x32x16_bf16 v[48:63], v[80:83], a[128:131], v[192:207]
    ds_read_b64_tr_b16 v[112:113], v164 offset:8192
    v_add_f32 v169, v169, v31
    v_cvt_pk_bf16_f32 v23, v30, v31
    v_exp_f32 v32, v32
    v_mfma_f32_32x32x16_bf16 v[64:79], v[80:83], a[160:163], v[208:223]
    ds_read_b64_tr_b16 v[114:115], v164 offset:10240
    v_exp_f32 v33, v33
    v_exp_f32 v34, v34
    v_mfma_f32_32x32x16_bf16 v[48:63], v[84:87], a[132:135], v[48:63]
    ds_read_b64_tr_b16 v[116:117], v165 offset:8192
    v_exp_f32 v35, v35
    v_add_f32 v173, v173, v32
    v_add_f32 v174, v174, v33
    v_mfma_f32_32x32x16_bf16 v[64:79], v[84:87], a[164:167], v[64:79]
    ds_read_b64_tr_b16 v[118:119], v165 offset:10240
    v_cvt_pk_bf16_f32 v32, v32, v33
    v_exp_f32 v36, v36
    v_mfma_f32_32x32x16_bf16 v[48:63], v[88:91], a[136:139], v[48:63]
    ds_read_b64_tr_b16 v[120:121], v166 offset:8192
    v_exp_f32 v37, v37
    v_add_f32 v173, v173, v34
    v_add_f32 v174, v174, v35
    v_mfma_f32_32x32x16_bf16 v[64:79], v[88:91], a[168:171], v[64:79]
    ds_read_b64_tr_b16 v[122:123], v166 offset:10240
    v_cvt_pk_bf16_f32 v33, v34, v35
    v_exp_f32 v38, v38
    v_mfma_f32_32x32x16_bf16 v[48:63], v[92:95], a[140:143], v[48:63]
    ds_read_b64_tr_b16 v[124:125], v167 offset:8192
    v_exp_f32 v39, v39
    v_add_f32 v173, v173, v36
    v_add_f32 v174, v174, v37
    v_mfma_f32_32x32x16_bf16 v[64:79], v[92:95], a[172:175], v[64:79]
    ds_read_b64_tr_b16 v[126:127], v167 offset:10240
    v_cvt_pk_bf16_f32 v34, v36, v37
    v_exp_f32 v40, v40
    v_mfma_f32_32x32x16_bf16 v[48:63], v[96:99], a[144:147], v[48:63]
    ds_read_b64_tr_b16 v[128:129], v164 offset:12288
    v_exp_f32 v41, v41
    v_add_f32 v173, v173, v38
    v_add_f32 v174, v174, v39
    v_mfma_f32_32x32x16_bf16 v[64:79], v[96:99], a[176:179], v[64:79]
    ds_read_b64_tr_b16 v[130:131], v164 offset:14336
    v_cvt_pk_bf16_f32 v35, v38, v39
    v_exp_f32 v42, v42
    v_mfma_f32_32x32x16_bf16 v[48:63], v[100:103], a[148:151], v[48:63]
    ds_read_b64_tr_b16 v[132:133], v165 offset:12288
    v_exp_f32 v43, v43
    v_add_f32 v173, v173, v40
    v_add_f32 v174, v174, v41
    v_mfma_f32_32x32x16_bf16 v[64:79], v[100:103], a[180:183], v[64:79]
    ds_read_b64_tr_b16 v[134:135], v165 offset:14336
    v_cvt_pk_bf16_f32 v36, v40, v41
    v_exp_f32 v44, v44
    v_mfma_f32_32x32x16_bf16 v[48:63], v[104:107], a[152:155], v[48:63]
    ds_read_b64_tr_b16 v[136:137], v166 offset:12288
    v_exp_f32 v45, v45
    v_add_f32 v173, v173, v42
    v_add_f32 v174, v174, v43
    v_mfma_f32_32x32x16_bf16 v[64:79], v[104:107], a[184:187], v[64:79]
    ds_read_b64_tr_b16 v[138:139], v166 offset:14336
    v_cvt_pk_bf16_f32 v37, v42, v43
    v_exp_f32 v46, v46
    v_mfma_f32_32x32x16_bf16 v[48:63], v[108:111], a[156:159], v[48:63]
    ds_read_b64_tr_b16 v[140:141], v167 offset:12288
    v_exp_f32 v47, v47
    v_add_f32 v173, v173, v44
    v_add_f32 v174, v174, v45
    v_mfma_f32_32x32x16_bf16 v[64:79], v[108:111], a[188:191], v[64:79]
    s_waitcnt lgkmcnt(14)
    ds_read_b64_tr_b16 v[142:143], v167 offset:14336
    v_cvt_pk_bf16_f32 v38, v44, v45
    v_add_f32 v173, v173, v46
    v_add_f32 v174, v174, v47
    v_cvt_pk_bf16_f32 v39, v46, v47
    s_add_u32 m0, s44, 32768
    s_nop 0
    buffer_load_dwordx4 v184, s[12:15], s38 offen lds
    buffer_load_dwordx4 v185, s[12:15], s38 offen offset:1024 lds
    s_add_u32 m0, s44, 40960
    s_nop 0
    buffer_load_dwordx4 v186, s[16:19], s38 offen lds
    buffer_load_dwordx4 v186, s[16:19], s38 offen offset:1024 lds
    s_add_u32 s38, s38, 8192
    s_cmp_eq_u32 s39, 0
    s_cbranch_scc1 L_ap27
    s_call_b64 s[40:41], L_apply
L_ap27:
    s_waitcnt lgkmcnt(8)
    v_mfma_f32_32x32x16_bf16 a[0:15], v[112:115], v[16:19], a[0:15]
    ds_read_b128 v[80:83], v152 offset:32768
    v_max3_f32 v171, v48, v49, v50
    v_max3_f32 v172, v51, v52, v53
    v_max3_f32 v171, v171, v54, v55
    v_max3_f32 v172, v172, v56, v57
    v_max3_f32 v171, v171, v58, v59
    v_mfma_f32_32x32x16_bf16 a[64:79], v[112:115], v[32:35], a[64:79]
    ds_read_b128 v[84:87], v153 offset:32768
    v_max3_f32 v172, v172, v60, v61
    v_max3_f32 v171, v171, v62, v63
    v_max_f32 v171, v171, v172
    v_max3_f32 v176, v64, v65, v66
    v_max3_f32 v177, v67, v68, v69
    v_mfma_f32_32x32x16_bf16 a[16:31], v[116:119], v[16:19], a[16:31]
    ds_read_b128 v[88:91], v154 offset:32768
    v_max3_f32 v176, v176, v70, v71
    v_max3_f32 v177, v177, v72, v73
    v_max3_f32 v176, v176, v74, v75
    v_max3_f32 v177, v177, v76, v77
    v_max3_f32 v176, v176, v78, v79
    v_mfma_f32_32x32x16_bf16 a[80:95], v[116:119], v[32:35], a[80:95]
    ds_read_b128 v[92:95], v155 offset:32768
    v_max_f32 v176, v176, v177
    v_cmp_lt_f32 vcc, s37, v171
    s_cbranch_vccz L_sk25
    s_call_b64 s[40:41], L_rare01
L_sk25:
    v_cmp_lt_f32 vcc, s37, v176
    s_cbranch_vccz L_sk26
    s_call_b64 s[40:41], L_rare11
L_sk26:
    v_mfma_f32_32x32x16_bf16 a[32:47], v[120:123], v[16:19], a[32:47]
    ds_read_b128 v[96:99], v156 offset:32768
    v_exp_f32 v48, v48
    v_exp_f32 v49, v49
    v_mfma_f32_32x32x16_bf16 a[96:111], v[120:123], v[32:35], a[96:111]
    ds_read_b128 v[100:103], v157 offset:32768
    v_exp_f32 v50, v50
    v_exp_f32 v51, v51
    v_add_f32 v168, v168, v48
    v_mfma_f32_32x32x16_bf16 a[48:63], v[124:127], v[16:19], a[48:63]
    ds_read_b128 v[104:107], v158 offset:32768
    v_add_f32 v169, v169, v49
    v_cvt_pk_bf16_f32 v48, v48, v49
    v_exp_f32 v52, v52
    v_mfma_f32_32x32x16_bf16 a[112:127], v[124:127], v[32:35], a[112:127]
    s_waitcnt lgkmcnt(14)
    ds_read_b128 v[108:111], v159 offset:32768
    v_exp_f32 v53, v53
    v_add_f32 v168, v168, v50
    v_add_f32 v169, v169, v51
    v_cvt_pk_bf16_f32 v49, v50, v51
    s_waitcnt lgkmcnt(8)
    v_mfma_f32_32x32x16_bf16 a[0:15], v[128:131], v[20:23], a[0:15]
    v_exp_f32 v54, v54
    v_exp_f32 v55, v55
    v_add_f32 v168, v168, v52
    v_add_f32 v169, v169, v53
    v_mfma_f32_32x32x16_bf16 a[64:79], v[128:131], v[36:39], a[64:79]
    s_add_u32 m0, s44, 49152
    s_nop 0
    buffer_load_dwordx4 v184, s[12:15], s38 offen lds
    buffer_load_dwordx4 v185, s[12:15], s38 offen offset:1024 lds
    v_mfma_f32_32x32x16_bf16 a[16:31], v[132:135], v[20:23], a[16:31]
    v_cvt_pk_bf16_f32 v50, v52, v53
    v_exp_f32 v56, v56
    v_exp_f32 v57, v57
    v_add_f32 v168, v168, v54
    v_mfma_f32_32x32x16_bf16 a[80:95], v[132:135], v[36:39], a[80:95]
    v_add_f32 v169, v169, v55
    v_cvt_pk_bf16_f32 v51, v54, v55
    v_exp_f32 v58, v58
    v_exp_f32 v59, v59
    v_mfma_f32_32x32x16_bf16 a[32:47], v[136:139], v[20:23], a[32:47]
    v_add_f32 v168, v168, v56
    v_add_f32 v169, v169, v57
    v_cvt_pk_bf16_f32 v52, v56, v57
    v_exp_f32 v60, v60
    v_mfma_f32_32x32x16_bf16 a[96:111], v[136:139], v[36:39], a[96:111]
    s_add_u32 m0, s44, 57344
    s_nop 0
    buffer_load_dwordx4 v186, s[16:19], s38 offen lds
    buffer_load_dwordx4 v186, s[16:19], s38 offen offset:1024 lds
    s_add_u32 s38, s38, 8192
    v_mfma_f32_32x32x16_bf16 a[48:63], v[140:143], v[20:23], a[48:63]
    v_exp_f32 v61, v61
    v_add_f32 v168, v168, v58
    v_add_f32 v169, v169, v59
    v_cvt_pk_bf16_f32 v53, v58, v59
    v_mfma_f32_32x32x16_bf16 a[112:127], v[140:143], v[36:39], a[112:127]
    v_exp_f32 v62, v62
    v_exp_f32 v63, v63
    v_add_f32 v168, v168, v60
    v_add_f32 v169, v169, v61
    v_cvt_pk_bf16_f32 v54, v60, v61
    v_add_f32 v168, v168, v62
    s_waitcnt lgkmcnt(0)
    v_mfma_f32_32x32x16_bf16 v[16:31], v[80:83], a[128:131], v[192:207]
    ds_read_b64_tr_b16 v[112:113], v164 offset:24576
    v_add_f32 v169, v169, v63
    v_cvt_pk_bf16_f32 v55, v62, v63
    v_exp_f32 v64, v64
    v_mfma_f32_32x32x16_bf16 v[32:47], v[80:83], a[160:163], v[208:223]
    ds_read_b64_tr_b16 v[114:115], v164 offset:26624
    v_exp_f32 v65, v65
    v_exp_f32 v66, v66
    v_mfma_f32_32x32x16_bf16 v[16:31], v[84:87], a[132:135], v[16:31]
    ds_read_b64_tr_b16 v[116:117], v165 offset:24576
    v_exp_f32 v67, v67
    v_add_f32 v173, v173, v64
    v_add_f32 v174, v174, v65
    v_mfma_f32_32x32x16_bf16 v[32:47], v[84:87], a[164:167], v[32:47]
    ds_read_b64_tr_b16 v[118:119], v165 offset:26624
    v_cvt_pk_bf16_f32 v64, v64, v65
    v_exp_f32 v68, v68
    v_mfma_f32_32x32x16_bf16 v[16:31], v[88:91], a[136:139], v[16:31]
    ds_read_b64_tr_b16 v[120:121], v166 offset:24576
    v_exp_f32 v69, v69
    v_add_f32 v173, v173, v66
    v_add_f32 v174, v174, v67
    v_mfma_f32_32x32x16_bf16 v[32:47], v[88:91], a[168:171], v[32:47]
    ds_read_b64_tr_b16 v[122:123], v166 offset:26624
    v_cvt_pk_bf16_f32 v65, v66, v67
    v_exp_f32 v70, v70
    v_mfma_f32_32x32x16_bf16 v[16:31], v[92:95], a[140:143], v[16:31]
    ds_read_b64_tr_b16 v[124:125], v167 offset:24576
    v_exp_f32 v71, v71
    v_add_f32 v173, v173, v68
    v_add_f32 v174, v174, v69
    v_mfma_f32_32x32x16_bf16 v[32:47], v[92:95], a[172:175], v[32:47]
    ds_read_b64_tr_b16 v[126:127], v167 offset:26624
    v_cvt_pk_bf16_f32 v66, v68, v69
    v_exp_f32 v72, v72
    v_mfma_f32_32x32x16_bf16 v[16:31], v[96:99], a[144:147], v[16:31]
    ds_read_b64_tr_b16 v[128:129], v164 offset:28672
    v_exp_f32 v73, v73
    v_add_f32 v173, v173, v70
    v_add_f32 v174, v174, v71
    v_mfma_f32_32x32x16_bf16 v[32:47], v[96:99], a[176:179], v[32:47]
    ds_read_b64_tr_b16 v[130:131], v164 offset:30720
    v_cvt_pk_bf16_f32 v67, v70, v71
    v_exp_f32 v74, v74
    v_mfma_f32_32x32x16_bf16 v[16:31], v[100:103], a[148:151], v[16:31]
    ds_read_b64_tr_b16 v[132:133], v165 offset:28672
    v_exp_f32 v75, v75
    v_add_f32 v173, v173, v72
    v_add_f32 v174, v174, v73
    v_mfma_f32_32x32x16_bf16 v[32:47], v[100:103], a[180:183], v[32:47]
    ds_read_b64_tr_b16 v[134:135], v165 offset:30720
    v_cvt_pk_bf16_f32 v68, v72, v73
    v_exp_f32 v76, v76
    v_mfma_f32_32x32x16_bf16 v[16:31], v[104:107], a[152:155], v[16:31]
    ds_read_b64_tr_b16 v[136:137], v166 offset:28672
    v_exp_f32 v77, v77
    v_add_f32 v173, v173, v74
    v_add_f32 v174, v174, v75
    v_mfma_f32_32x32x16_bf16 v[32:47], v[104:107], a[184:187], v[32:47]
    ds_read_b64_tr_b16 v[138:139], v166 offset:30720
    v_cvt_pk_bf16_f32 v69, v74, v75
    v_exp_f32 v78, v78
    v_mfma_f32_32x32x16_bf16 v[16:31], v[108:111], a[156:159], v[16:31]
    ds_read_b64_tr_b16 v[140:141], v167 offset:28672
    v_exp_f32 v79, v79
    v_add_f32 v173, v173, v76
    v_add_f32 v174, v174, v77
    v_mfma_f32_32x32x16_bf16 v[32:47], v[108:111], a[188:191], v[32:47]
    s_waitcnt lgkmcnt(14)
    ds_read_b64_tr_b16 v[142:143], v167 offset:30720
    v_cvt_pk_bf16_f32 v70, v76, v77
    v_add_f32 v173, v173, v78
    v_add_f32 v174, v174, v79
    v_cvt_pk_bf16_f32 v71, v78, v79
    s_cmp_eq_u32 s39, 0
    s_cbranch_scc1 L_ap32
    s_call_b64 s[40:41], L_apply
L_ap32:
    s_waitcnt lgkmcnt(8)
    v_mfma_f32_32x32x16_bf16 a[0:15], v[112:115], v[48:51], a[0:15]
    ds_read_b128 v[80:83], v152 offset:49152
    v_max3_f32 v171, v16, v17, v18
    v_max3_f32 v172, v19, v20, v21
    v_max3_f32 v171, v171, v22, v23
    v_max3_f32 v172, v172, v24, v25
    v_max3_f32 v171, v171, v26, v27
    v_mfma_f32_32x32x16_bf16 a[64:79], v[112:115], v[64:67], a[64:79]
    ds_read_b128 v[84:87], v153 offset:49152
    v_max3_f32 v172, v172, v28, v29
    v_max3_f32 v171, v171, v30, v31
    v_max_f32 v171, v171, v172
    v_max3_f32 v176, v32, v33, v34
    v_max3_f32 v177, v35, v36, v37
    v_mfma_f32_32x32x16_bf16 a[16:31], v[116:119], v[48:51], a[16:31]
    ds_read_b128 v[88:91], v154 offset:49152
    v_max3_f32 v176, v176, v38, v39
    v_max3_f32 v177, v177, v40, v41
    v_max3_f32 v176, v176, v42, v43
    v_max3_f32 v177, v177, v44, v45
    v_max3_f32 v176, v176, v46, v47
    v_mfma_f32_32x32x16_bf16 a[80:95], v[116:119], v[64:67], a[80:95]
    ds_read_b128 v[92:95], v155 offset:49152
    v_max_f32 v176, v176, v177
    v_cmp_lt_f32 vcc, s37, v171
    s_cbranch_vccz L_sk30
    s_call_b64 s[40:41], L_rare00
L_sk30:
    v_cmp_lt_f32 vcc, s37, v176
    s_cbranch_vccz L_sk31
    s_call_b64 s[40:41], L_rare10
L_sk31:
    v_mfma_f32_32x32x16_bf16 a[32:47], v[120:123], v[48:51], a[32:47]
    ds_read_b128 v[96:99], v156 offset:49152
    v_exp_f32 v16, v16
    v_exp_f32 v17, v17
    v_mfma_f32_32x32x16_bf16 a[96:111], v[120:123], v[64:67], a[96:111]
    ds_read_b128 v[100:103], v157 offset:49152
    v_exp_f32 v18, v18
    v_exp_f32 v19, v19
    v_add_f32 v168, v168, v16
    v_mfma_f32_32x32x16_bf16 a[48:63], v[124:127], v[48:51], a[48:63]
    ds_read_b128 v[104:107], v158 offset:49152
    v_add_f32 v169, v169, v17
    v_cvt_pk_bf16_f32 v16, v16, v17
    v_exp_f32 v20, v20
    v_mfma_f32_32x32x16_bf16 a[112:127], v[124:127], v[64:67], a[112:127]
    s_waitcnt lgkmcnt(14)
    ds_read_b128 v[108:111], v159 offset:49152
    v_exp_f32 v21, v21
    v_add_f32 v168, v168, v18
    v_add_f32 v169, v169, v19
    v_cvt_pk_bf16_f32 v17, v18, v19
    s_waitcnt lgkmcnt(8)
    v_mfma_f32_32x32x16_bf16 a[0:15], v[128:131], v[52:55], a[0:15]
    v_exp_f32 v22, v22
    v_exp_f32 v23, v23
    v_add_f32 v168, v168, v20
    v_add_f32 v169, v169, v21
    v_mfma_f32_32x32x16_bf16 a[64:79], v[128:131], v[68:71], a[64:79]
    v_cvt_pk_bf16_f32 v18, v20, v21
    v_exp_f32 v24, v24
    v_exp_f32 v25, v25
    v_add_f32 v168, v168, v22
    v_mfma_f32_32x32x16_bf16 a[16:31], v[132:135], v[52:55], a[16:31]
    v_add_f32 v169, v169, v23
    v_cvt_pk_bf16_f32 v19, v22, v23
    v_exp_f32 v26, v26
    v_exp_f32 v27, v27
    v_mfma_f32_32x32x16_bf16 a[80:95], v[132:135], v[68:71], a[80:95]
    v_add_f32 v168, v168, v24
    v_add_f32 v169, v169, v25
    v_cvt_pk_bf16_f32 v20, v24, v25
    v_exp_f32 v28, v28
    v_mfma_f32_32x32x16_bf16 a[32:47], v[136:139], v[52:55], a[32:47]
    v_exp_f32 v29, v29
    v_add_f32 v168, v168, v26
    v_add_f32 v169, v169, v27
    v_cvt_pk_bf16_f32 v21, v26, v27
    v_mfma_f32_32x32x16_bf16 a[96:111], v[136:139], v[68:71], a[96:111]
    v_exp_f32 v30, v30
    v_exp_f32 v31, v31
    v_add_f32 v168, v168, v28
    v_add_f32 v169, v169, v29
    v_mfma_f32_32x32x16_bf16 a[48:63], v[140:143], v[52:55], a[48:63]
    v_cvt_pk_bf16_f32 v22, v28, v29
    v_add_f32 v168, v168, v30
    v_mfma_f32_32x32x16_bf16 a[112:127], v[140:143], v[68:71], a[112:127]
    s_waitcnt vmcnt(8)
    s_barrier
    s_waitcnt lgkmcnt(0)
    v_mfma_f32_32x32x16_bf16 v[48:63], v[80:83], a[128:131], v[192:207]
    ds_read_b64_tr_b16 v[112:113], v164 offset:40960
    v_add_f32 v169, v169, v31
    v_cvt_pk_bf16_f32 v23, v30, v31
    v_exp_f32 v32, v32
    v_mfma_f32_32x32x16_bf16 v[64:79], v[80:83], a[160:163], v[208:223]
    ds_read_b64_tr_b16 v[114:115], v164 offset:43008
    v_exp_f32 v33, v33
    v_exp_f32 v34, v34
    v_mfma_f32_32x32x16_bf16 v[48:63], v[84:87], a[132:135], v[48:63]
    ds_read_b64_tr_b16 v[116:117], v165 offset:40960
    v_exp_f32 v35, v35
    v_add_f32 v173, v173, v32
    v_add_f32 v174, v174, v33
    v_mfma_f32_32x32x16_bf16 v[64:79], v[84:87], a[164:167], v[64:79]
    ds_read_b64_tr_b16 v[118:119], v165 offset:43008
    v_cvt_pk_bf16_f32 v32, v32, v33
    v_exp_f32 v36, v36
    v_mfma_f32_32x32x16_bf16 v[48:63], v[88:91], a[136:139], v[48:63]
    ds_read_b64_tr_b16 v[120:121], v166 offset:40960
    v_exp_f32 v37, v37
    v_add_f32 v173, v173, v34
    v_add_f32 v174, v174, v35
    v_mfma_f32_32x32x16_bf16 v[64:79], v[88:91], a[168:171], v[64:79]
    ds_read_b64_tr_b16 v[122:123], v166 offset:43008
    v_cvt_pk_bf16_f32 v33, v34, v35
    v_exp_f32 v38, v38
    v_mfma_f32_32x32x16_bf16 v[48:63], v[92:95], a[140:143], v[48:63]
    ds_read_b64_tr_b16 v[124:125], v167 offset:40960
    v_exp_f32 v39, v39
    v_add_f32 v173, v173, v36
    v_add_f32 v174, v174, v37
    v_mfma_f32_32x32x16_bf16 v[64:79], v[92:95], a[172:175], v[64:79]
    ds_read_b64_tr_b16 v[126:127], v167 offset:43008
    v_cvt_pk_bf16_f32 v34, v36, v37
    v_exp_f32 v40, v40
    v_mfma_f32_32x32x16_bf16 v[48:63], v[96:99], a[144:147], v[48:63]
    ds_read_b64_tr_b16 v[128:129], v164 offset:45056
    v_exp_f32 v41, v41
    v_add_f32 v173, v173, v38
    v_add_f32 v174, v174, v39
    v_mfma_f32_32x32x16_bf16 v[64:79], v[96:99], a[176:179], v[64:79]
    ds_read_b64_tr_b16 v[130:131], v164 offset:47104
    v_cvt_pk_bf16_f32 v35, v38, v39
    v_exp_f32 v42, v42
    v_mfma_f32_32x32x16_bf16 v[48:63], v[100:103], a[148:151], v[48:63]
    ds_read_b64_tr_b16 v[132:133], v165 offset:45056
    v_exp_f32 v43, v43
    v_add_f32 v173, v173, v40
    v_add_f32 v174, v174, v41
    v_mfma_f32_32x32x16_bf16 v[64:79], v[100:103], a[180:183], v[64:79]
    ds_read_b64_tr_b16 v[134:135], v165 offset:47104
    v_cvt_pk_bf16_f32 v36, v40, v41
    v_exp_f32 v44, v44
    v_mfma_f32_32x32x16_bf16 v[48:63], v[104:107], a[152:155], v[48:63]
    ds_read_b64_tr_b16 v[136:137], v166 offset:45056
    v_exp_f32 v45, v45
    v_add_f32 v173, v173, v42
    v_add_f32 v174, v174, v43
    v_mfma_f32_32x32x16_bf16 v[64:79], v[104:107], a[184:187], v[64:79]
    ds_read_b64_tr_b16 v[138:139], v166 offset:47104
    v_cvt_pk_bf16_f32 v37, v42, v43
    v_exp_f32 v46, v46
    v_mfma_f32_32x32x16_bf16 v[48:63], v[108:111], a[156:159], v[48:63]
    ds_read_b64_tr_b16 v[140:141], v167 offset:45056
    v_exp_f32 v47, v47
    v_add_f32 v173, v173, v44
    v_add_f32 v174, v174, v45
    v_mfma_f32_32x32x16_bf16 v[64:79], v[108:111], a[188:191], v[64:79]
    s_waitcnt lgkmcnt(14)
    ds_read_b64_tr_b16 v[142:143], v167 offset:47104
    v_cvt_pk_bf16_f32 v38, v44, v45
    v_add_f32 v173, v173, v46
    v_add_f32 v174, v174, v47
    v_cvt_pk_bf16_f32 v39, v46, v47
    s_add_u32 m0, s44, 65536
    s_nop 0
    buffer_load_dwordx4 v184, s[12:15], s38 offen lds
    buffer_load_dwordx4 v185, s[12:15], s38 offen offset:1024 lds
    s_add_u32 m0, s44, 73728
    s_nop 0
    buffer_load_dwordx4 v186, s[16:19], s38 offen lds
    buffer_load_dwordx4 v186, s[16:19], s38 offen offset:1024 lds
    s_add_u32 s38, s38, 8192
    s_cmp_eq_u32 s39, 0
    s_cbranch_scc1 L_ap37
    s_call_b64 s[40:41], L_apply
L_ap37:
    s_waitcnt lgkmcnt(8)
    v_mfma_f32_32x32x16_bf16 a[0:15], v[112:115], v[16:19], a[0:15]
    ds_read_b128 v[80:83], v144 offset:0
    v_max3_f32 v171, v48, v49, v50
    v_max3_f32 v172, v51, v52, v53
    v_max3_f32 v171, v171, v54, v55
    v_max3_f32 v172, v172, v56, v57
    v_max3_f32 v171, v171, v58, v59
    v_mfma_f32_32x32x16_bf16 a[64:79], v[112:115], v[32:35], a[64:79]
    ds_read_b128 v[84:87], v145 offset:0
    v_max3_f32 v172, v172, v60, v61
    v_max3_f32 v171, v171, v62, v63
    v_max_f32 v171, v171, v172
    v_max3_f32 v176, v64, v65, v66
    v_max3_f32 v177, v67, v68, v69
    v_mfma_f32_32x32x16_bf16 a[16:31], v[116:119], v[16:19], a[16:31]
    ds_read_b128 v[88:91], v146 offset:0
    v_max3_f32 v176, v176, v70, v71
    v_max3_f32 v177, v177, v72, v73
    v_max3_f32 v176, v176, v74, v75
    v_max3_f32 v177, v177, v76, v77
    v_max3_f32 v176, v176, v78, v79
    v_mfma_f32_32x32x16_bf16 a[80:95], v[116:119], v[32:35], a[80:95]
    ds_read_b128 v[92:95], v147 offset:0
    v_max_f32 v176, v176, v177
    v_cmp_lt_f32 vcc, s37, v171
    s_cbranch_vccz L_sk35
    s_call_b64 s[40:41], L_rare01
L_sk35:
    v_cmp_lt_f32 vcc, s37, v176
    s_cbranch_vccz L_sk36
    s_call_b64 s[40:41], L_rare11
L_sk36:
    v_mfma_f32_32x32x16_bf16 a[32:47], v[120:123], v[16:19], a[32:47]
    ds_read_b128 v[96:99], v148 offset:0
    v_exp_f32 v48, v48
    v_exp_f32 v49, v49
    v_mfma_f32_32x32x16_bf16 a[96:111], v[120:123], v[32:35], a[96:111]
    ds_read_b128 v[100:103], v149 offset:0
    v_exp_f32 v50, v50
    v_exp_f32 v51, v51
    v_add_f32 v168, v168, v48
    v_mfma_f32_32x32x16_bf16 a[48:63], v[124:127], v[16:19], a[48:63]
    ds_read_b128 v[104:107], v150 offset:0
    v_add_f32 v169, v169, v49
    v_cvt_pk_bf16_f32 v48, v48, v49
    v_exp_f32 v52, v52
    v_mfma_f32_32x32x16_bf16 a[112:127], v[124:127], v[32:35], a[112:127]
    s_waitcnt lgkmcnt(14)
    ds_read_b128 v[108:111], v151 offset:0
    v_exp_f32 v53, v53
    v_add_f32 v168, v168, v50
    v_add_f32 v169, v169, v51
    v_cvt_pk_bf16_f32 v49, v50, v51
    s_waitcnt lgkmcnt(8)
    v_mfma_f32_32x32x16_bf16 a[0:15], v[128:131], v[20:23], a[0:15]
    v_exp_f32 v54, v54
    v_exp_f32 v55, v55
    v_add_f32 v168, v168, v52
    v_add_f32 v169, v169, v53
    v_mfma_f32_32x32x16_bf16 a[64:79], v[128:131], v[36:39], a[64:79]
    s_add_u32 m0, s44, 81920
    s_nop 0
    buffer_load_dwordx4 v184, s[12:15], s38 offen lds
    buffer_load_dwordx4 v185, s[12:15], s38 offen offset:1024 lds
    v_mfma_f32_32x32x16_bf16 a[16:31], v[132:135], v[20:23], a[16:31]
    v_cvt_pk_bf16_f32 v50, v52, v53
    v_exp_f32 v56, v56
    v_exp_f32 v57, v57
    v_add_f32 v168, v168, v54
    v_mfma_f32_32x32x16_bf16 a[80:95], v[132:135], v[36:39], a[80:95]
    v_add_f32 v169, v169, v55
    v_cvt_pk_bf16_f32 v51, v54, v55
    v_exp_f32 v58, v58
    v_exp_f32 v59, v59
    v_mfma_f32_32x32x16_bf16 a[32:47], v[136:139], v[20:23], a[32:47]
    v_add_f32 v168, v168, v56
    v_add_f32 v169, v169, v57
    v_cvt_pk_bf16_f32 v52, v56, v57
    v_exp_f32 v60, v60
    v_mfma_f32_32x32x16_bf16 a[96:111], v[136:139], v[36:39], a[96:111]
    s_add_u32 m0, s44, 90112
    s_nop 0
    buffer_load_dwordx4 v186, s[16:19], s38 offen lds
    buffer_load_dwordx4 v186, s[16:19], s38 offen offset:1024 lds
    s_add_u32 s38, s38, 8192
    v_mfma_f32_32x32x16_bf16 a[48:63], v[140:143], v[20:23], a[48:63]
    v_exp_f32 v61, v61
    v_add_f32 v168, v168, v58
    v_add_f32 v169, v169, v59
    v_cvt_pk_bf16_f32 v53, v58, v59
    v_mfma_f32_32x32x16_bf16 a[112:127], v[140:143], v[36:39], a[112:127]
    v_exp_f32 v62, v62
    v_exp_f32 v63, v63
    v_add_f32 v168, v168, v60
    v_add_f32 v169, v169, v61
    v_cvt_pk_bf16_f32 v54, v60, v61
    v_add_f32 v168, v168, v62
    s_waitcnt lgkmcnt(0)
    v_mfma_f32_32x32x16_bf16 v[16:31], v[80:83], a[128:131], v[192:207]
    ds_read_b64_tr_b16 v[112:113], v164 offset:57344
    v_add_f32 v169, v169, v63
    v_cvt_pk_bf16_f32 v55, v62, v63
    v_exp_f32 v64, v64
    v_mfma_f32_32x32x16_bf16 v[32:47], v[80:83], a[160:163], v[208:223]
    ds_read_b64_tr_b16 v[114:115], v164 offset:59392
    v_exp_f32 v65, v65
    v_exp_f32 v66, v66
    v_mfma_f32_32x32x16_bf16 v[16:31], v[84:87], a[132:135], v[16:31]
    ds_read_b64_tr_b16 v[116:117], v165 offset:57344
    v_exp_f32 v67, v67
    v_add_f32 v173, v173, v64
    v_add_f32 v174, v174, v65
    v_mfma_f32_32x32x16_bf16 v[32:47], v[84:87], a[164:167], v[32:47]
    ds_read_b64_tr_b16 v[118:119], v165 offset:59392
    v_cvt_pk_bf16_f32 v64, v64, v65
    v_exp_f32 v68, v68
    v_mfma_f32_32x32x16_bf16 v[16:31], v[88:91], a[136:139], v[16:31]
    ds_read_b64_tr_b16 v[120:121], v166 offset:57344
    v_exp_f32 v69, v69
    v_add_f32 v173, v173, v66
    v_add_f32 v174, v174, v67
    v_mfma_f32_32x32x16_bf16 v[32:47], v[88:91], a[168:171], v[32:47]
    ds_read_b64_tr_b16 v[122:123], v166 offset:59392
    v_cvt_pk_bf16_f32 v65, v66, v67
    v_exp_f32 v70, v70
    v_mfma_f32_32x32x16_bf16 v[16:31], v[92:95], a[140:143], v[16:31]
    ds_read_b64_tr_b16 v[124:125], v167 offset:57344
    v_exp_f32 v71, v71
    v_add_f32 v173, v173, v68
    v_add_f32 v174, v174, v69
    v_mfma_f32_32x32x16_bf16 v[32:47], v[92:95], a[172:175], v[32:47]
    ds_read_b64_tr_b16 v[126:127], v167 offset:59392
    v_cvt_pk_bf16_f32 v66, v68, v69
    v_exp_f32 v72, v72
    v_mfma_f32_32x32x16_bf16 v[16:31], v[96:99], a[144:147], v[16:31]
    ds_read_b64_tr_b16 v[128:129], v164 offset:61440
    v_exp_f32 v73, v73
    v_add_f32 v173, v173, v70
    v_add_f32 v174, v174, v71
    v_mfma_f32_32x32x16_bf16 v[32:47], v[96:99], a[176:179], v[32:47]
    ds_read_b64_tr_b16 v[130:131], v164 offset:63488
    v_cvt_pk_bf16_f32 v67, v70, v71
    v_exp_f32 v74, v74
    v_mfma_f32_32x32x16_bf16 v[16:31], v[100:103], a[148:151], v[16:31]
    ds_read_b64_tr_b16 v[132:133], v165 offset:61440
    v_exp_f32 v75, v75
    v_add_f32 v173, v173, v72
    v_add_f32 v174, v174, v73
    v_mfma_f32_32x32x16_bf16 v[32:47], v[100:103], a[180:183], v[32:47]
    ds_read_b64_tr_b16 v[134:135], v165 offset:63488
    v_cvt_pk_bf16_f32 v68, v72, v73
    v_exp_f32 v76, v76
    v_mfma_f32_32x32x16_bf16 v[16:31], v[104:107], a[152:155], v[16:31]
    ds_read_b64_tr_b16 v[136:137], v166 offset:61440
    v_exp_f32 v77, v77
    v_add_f32 v173, v173, v74
    v_add_f32 v174, v174, v75
    v_mfma_f32_32x32x16_bf16 v[32:47], v[104:107], a[184:187], v[32:47]
    ds_read_b64_tr_b16 v[138:139], v166 offset:63488
    v_cvt_pk_bf16_f32 v69, v74, v75
    v_exp_f32 v78, v78
    v_mfma_f32_32x32x16_bf16 v[16:31], v[108:111], a[156:159], v[16:31]
    ds_read_b64_tr_b16 v[140:141], v167 offset:61440
    v_exp_f32 v79, v79
    v_add_f32 v173, v173, v76
    v_add_f32 v174, v174, v77
    v_mfma_f32_32x32x16_bf16 v[32:47], v[108:111], a[188:191], v[32:47]
    s_waitcnt lgkmcnt(14)
    ds_read_b64_tr_b16 v[142:143], v167 offset:63488
    v_cvt_pk_bf16_f32 v70, v76, v77
    v_add_f32 v173, v173, v78
    v_add_f32 v174, v174, v79
    v_cvt_pk_bf16_f32 v71, v78, v79
    s_cmp_eq_u32 s39, 0
    s_cbranch_scc1 L_ap42
    s_call_b64 s[40:41], L_apply
L_ap42:
    s_waitcnt lgkmcnt(8)
    v_mfma_f32_32x32x16_bf16 a[0:15], v[112:115], v[48:51], a[0:15]
    ds_read_b128 v[80:83], v144 offset:16384
    v_max3_f32 v171, v16, v17, v18
    v_max3_f32 v172, v19, v20, v21
    v_max3_f32 v171, v171, v22, v23
    v_max3_f32 v172, v172, v24, v25
    v_max3_f32 v171, v171, v26, v27
    v_mfma_f32_32x32x16_bf16 a[64:79], v[112:115], v[64:67], a[64:79]
    ds_read_b128 v[84:87], v145 offset:16384
    v_max3_f32 v172, v172, v28, v29
    v_max3_f32 v171, v171, v30, v31
    v_max_f32 v171, v171, v172
    v_max3_f32 v176, v32, v33, v34
    v_max3_f32 v177, v35, v36, v37
    v_mfma_f32_32x32x16_bf16 a[16:31], v[116:119], v[48:51], a[16:31]
    ds_read_b128 v[88:91], v146 offset:16384
    v_max3_f32 v176, v176, v38, v39
    v_max3_f32 v177, v177, v40, v41
    v_max3_f32 v176, v176, v42, v43
    v_max3_f32 v177, v177, v44, v45
    v_max3_f32 v176, v176, v46, v47
    v_mfma_f32_32x32x16_bf16 a[80:95], v[116:119], v[64:67], a[80:95]
    ds_read_b128 v[92:95], v147 offset:16384
    v_max_f32 v176, v176, v177
    v_cmp_lt_f32 vcc, s37, v171
    s_cbranch_vccz L_sk40
    s_call_b64 s[40:41], L_rare00
L_sk40:
    v_cmp_lt_f32 vcc, s37, v176
    s_cbranch_vccz L_sk41
    s_call_b64 s[40:41], L_rare10
L_sk41:
    v_mfma_f32_32x32x16_bf16 a[32:47], v[120:123], v[48:51], a[32:47]
    ds_read_b128 v[96:99], v148 offset:16384
    v_exp_f32 v16, v16
    v_exp_f32 v17, v17
    v_mfma_f32_32x32x16_bf16 a[96:111], v[120:123], v[64:67], a[96:111]
    ds_read_b128 v[100:103], v149 offset:16384
    v_exp_f32 v18, v18
    v_exp_f32 v19, v19
    v_add_f32 v168, v168, v16
    v_mfma_f32_32x32x16_bf16 a[48:63], v[124:127], v[48:51], a[48:63]
    ds_read_b128 v[104:107], v150 offset:16384
    v_add_f32 v169, v169, v17
    v_cvt_pk_bf16_f32 v16, v16, v17
    v_exp_f32 v20, v20
    v_mfma_f32_32x32x16_bf16 a[112:127], v[124:127], v[64:67], a[112:127]
    s_waitcnt lgkmcnt(14)
    ds_read_b128 v[108:111], v151 offset:16384
    v_exp_f32 v21, v21
    v_add_f32 v168, v168, v18
    v_add_f32 v169, v169, v19
    v_cvt_pk_bf16_f32 v17, v18, v19
    s_waitcnt lgkmcnt(8)
    v_mfma_f32_32x32x16_bf16 a[0:15], v[128:131], v[52:55], a[0:15]
    v_exp_f32 v22, v22
    v_exp_f32 v23, v23
    v_add_f32 v168, v168, v20
    v_add_f32 v169, v169, v21
    v_mfma_f32_32x32x16_bf16 a[64:79], v[128:131], v[68:71], a[64:79]
    v_cvt_pk_bf16_f32 v18, v20, v21
    v_exp_f32 v24, v24
    v_exp_f32 v25, v25
    v_add_f32 v168, v168, v22
    v_mfma_f32_32x32x16_bf16 a[16:31], v[132:135], v[52:55], a[16:31]
    v_add_f32 v169, v169, v23
    v_cvt_pk_bf16_f32 v19, v22, v23
    v_exp_f32 v26, v26
    v_exp_f32 v27, v27
    v_mfma_f32_32x32x16_bf16 a[80:95], v[132:135], v[68:71], a[80:95]
    v_add_f32 v168, v168, v24
    v_add_f32 v169, v169, v25
    v_cvt_pk_bf16_f32 v20, v24, v25
    v_exp_f32 v28, v28
    v_mfma_f32_32x32x16_bf16 a[32:47], v[136:139], v[52:55], a[32:47]
    v_exp_f32 v29, v29
    v_add_f32 v168, v168, v26
    v_add_f32 v169, v169, v27
    v_cvt_pk_bf16_f32 v21, v26, v27
    v_mfma_f32_32x32x16_bf16 a[96:111], v[136:139], v[68:71], a[96:111]
    v_exp_f32 v30, v30
    v_exp_f32 v31, v31
    v_add_f32 v168, v168, v28
    v_add_f32 v169, v169, v29
    v_mfma_f32_32x32x16_bf16 a[48:63], v[140:143], v[52:55], a[48:63]
    v_cvt_pk_bf16_f32 v22, v28, v29
    v_add_f32 v168, v168, v30
    v_mfma_f32_32x32x16_bf16 a[112:127], v[140:143], v[68:71], a[112:127]
    s_sub_u32 s42, s42, 1
    s_cmp_lg_u32 s42, 0
    s_cbranch_scc1 L_loop
    s_waitcnt vmcnt(8)
    s_barrier
    s_waitcnt lgkmcnt(0)
    v_mfma_f32_32x32x16_bf16 v[48:63], v[80:83], a[128:131], v[192:207]
    ds_read_b64_tr_b16 v[112:113], v160 offset:8192
    v_add_f32 v169, v169, v31
    v_cvt_pk_bf16_f32 v23, v30, v31
    v_exp_f32 v32, v32
    v_mfma_f32_32x32x16_bf16 v[64:79], v[80:83], a[160:163], v[208:223]
    ds_read_b64_tr_b16 v[114:115], v160 offset:10240
    v_exp_f32 v33, v33
    v_exp_f32 v34, v34
    v_mfma_f32_32x32x16_bf16 v[48:63], v[84:87], a[132:135], v[48:63]
    ds_read_b64_tr_b16 v[116:117], v161 offset:8192
    v_exp_f32 v35, v35
    v_add_f32 v173, v173, v32
    v_add_f32 v174, v174, v33
    v_mfma_f32_32x32x16_bf16 v[64:79], v[84:87], a[164:167], v[64:79]
    ds_read_b64_tr_b16 v[118:119], v161 offset:10240
    v_cvt_pk_bf16_f32 v32, v32, v33
    v_exp_f32 v36, v36
    v_mfma_f32_32x32x16_bf16 v[48:63], v[88:91], a[136:139], v[48:63]
    ds_read_b64_tr_b16 v[120:121], v162 offset:8192
    v_exp_f32 v37, v37
    v_add_f32 v173, v173, v34
    v_add_f32 v174, v174, v35
    v_mfma_f32_32x32x16_bf16 v[64:79], v[88:91], a[168:171], v[64:79]
    ds_read_b64_tr_b16 v[122:123], v162 offset:10240
    v_cvt_pk_bf16_f32 v33, v34, v35
    v_exp_f32 v38, v38
    v_mfma_f32_32x32x16_bf16 v[48:63], v[92:95], a[140:143], v[48:63]
    ds_read_b64_tr_b16 v[124:125], v163 offset:8192
    v_exp_f32 v39, v39
    v_add_f32 v173, v173, v36
    v_add_f32 v174, v174, v37
    v_mfma_f32_32x32x16_bf16 v[64:79], v[92:95], a[172:175], v[64:79]
    ds_read_b64_tr_b16 v[126:127], v163 offset:10240
    v_cvt_pk_bf16_f32 v34, v36, v37
    v_exp_f32 v40, v40
    v_mfma_f32_32x32x16_bf16 v[48:63], v[96:99], a[144:147], v[48:63]
    ds_read_b64_tr_b16 v[128:129], v160 offset:12288
    v_exp_f32 v41, v41
    v_add_f32 v173, v173, v38
    v_add_f32 v174, v174, v39
    v_mfma_f32_32x32x16_bf16 v[64:79], v[96:99], a[176:179], v[64:79]
    ds_read_b64_tr_b16 v[130:131], v160 offset:14336
    v_cvt_pk_bf16_f32 v35, v38, v39
    v_exp_f32 v42, v42
    v_mfma_f32_32x32x16_bf16 v[48:63], v[100:103], a[148:151], v[48:63]
    ds_read_b64_tr_b16 v[132:133], v161 offset:12288
    v_exp_f32 v43, v43
    v_add_f32 v173, v173, v40
    v_add_f32 v174, v174, v41
    v_mfma_f32_32x32x16_bf16 v[64:79], v[100:103], a[180:183], v[64:79]
    ds_read_b64_tr_b16 v[134:135], v161 offset:14336
    v_cvt_pk_bf16_f32 v36, v40, v41
    v_exp_f32 v44, v44
    v_mfma_f32_32x32x16_bf16 v[48:63], v[104:107], a[152:155], v[48:63]
    ds_read_b64_tr_b16 v[136:137], v162 offset:12288
    v_exp_f32 v45, v45
    v_add_f32 v173, v173, v42
    v_add_f32 v174, v174, v43
    v_mfma_f32_32x32x16_bf16 v[64:79], v[104:107], a[184:187], v[64:79]
    ds_read_b64_tr_b16 v[138:139], v162 offset:14336
    v_cvt_pk_bf16_f32 v37, v42, v43
    v_exp_f32 v46, v46
    v_mfma_f32_32x32x16_bf16 v[48:63], v[108:111], a[156:159], v[48:63]
    ds_read_b64_tr_b16 v[140:141], v163 offset:12288
    v_exp_f32 v47, v47
    v_add_f32 v173, v173, v44
    v_add_f32 v174, v174, v45
    v_mfma_f32_32x32x16_bf16 v[64:79], v[108:111], a[188:191], v[64:79]
    s_waitcnt lgkmcnt(14)
    ds_read_b64_tr_b16 v[142:143], v163 offset:14336
    v_cvt_pk_bf16_f32 v38, v44, v45
    v_add_f32 v173, v173, v46
    v_add_f32 v174, v174, v47
    v_cvt_pk_bf16_f32 v39, v46, v47
    s_add_u32 m0, s44, 98304
    s_nop 0
    buffer_load_dwordx4 v184, s[12:15], s38 offen lds
    buffer_load_dwordx4 v185, s[12:15], s38 offen offset:1024 lds
    s_add_u32 m0, s44, 106496
    s_nop 0
    buffer_load_dwordx4 v186, s[16:19], s38 offen lds
    buffer_load_dwordx4 v186, s[16:19], s38 offen offset:1024 lds
    s_add_u32 s38, s38, 8192
    s_cmp_eq_u32 s39, 0
    s_cbranch_scc1 L_ap47
    s_call_b64 s[40:41], L_apply
L_ap47:
    s_waitcnt lgkmcnt(8)
    v_mfma_f32_32x32x16_bf16 a[0:15], v[112:115], v[16:19], a[0:15]
    ds_read_b128 v[80:83], v144 offset:32768
    v_max3_f32 v171, v48, v49, v50
    v_max3_f32 v172, v51, v52, v53
    v_max3_f32 v171, v171, v54, v55
    v_max3_f32 v172, v172, v56, v57
    v_max3_f32 v171, v171, v58, v59
    v_mfma_f32_32x32x16_bf16 a[64:79], v[112:115], v[32:35], a[64:79]
    ds_read_b128 v[84:87], v145 offset:32768
    v_max3_f32 v172, v172, v60, v61
    v_max3_f32 v171, v171, v62, v63
    v_max_f32 v171, v171, v172
    v_max3_f32 v176, v64, v65, v66
    v_max3_f32 v177, v67, v68, v69
    v_mfma_f32_32x32x16_bf16 a[16:31], v[116:119], v[16:19], a[16:31]
    ds_read_b128 v[88:91], v146 offset:32768
    v_max3_f32 v176, v176, v70, v71
    v_max3_f32 v177, v177, v72, v73
    v_max3_f32 v176, v176, v74, v75
    v_max3_f32 v177, v177, v76, v77
    v_max3_f32 v176, v176, v78, v79
    v_mfma_f32_32x32x16_bf16 a[80:95], v[116:119], v[32:35], a[80:95]
    ds_read_b128 v[92:95], v147 offset:32768
    v_max_f32 v176, v176, v177
    v_cmp_lt_f32 vcc, s37, v171
    s_cbranch_vccz L_sk45
    s_call_b64 s[40:41], L_rare01
L_sk45:
    v_cmp_lt_f32 vcc, s37, v176
    s_cbranch_vccz L_sk46
    s_call_b64 s[40:41], L_rare11
L_sk46:
    v_mfma_f32_32x32x16_bf16 a[32:47], v[120:123], v[16:19], a[32:47]
    ds_read_b128 v[96:99], v148 offset:32768
    v_exp_f32 v48, v48
    v_exp_f32 v49, v49
    v_mfma_f32_32x32x16_bf16 a[96:111], v[120:123], v[32:35], a[96:111]
    ds_read_b128 v[100:103], v149 offset:32768
    v_exp_f32 v50, v50
    v_exp_f32 v51, v51
    v_add_f32 v168, v168, v48
    v_mfma_f32_32x32x16_bf16 a[48:63], v[124:127], v[16:19], a[48:63]
    ds_read_b128 v[104:107], v150 offset:32768
    v_add_f32 v169, v169, v49
    v_cvt_pk_bf16_f32 v48, v48, v49
    v_exp_f32 v52, v52
    v_mfma_f32_32x32x16_bf16 a[112:127], v[124:127], v[32:35], a[112:127]
    s_waitcnt lgkmcnt(14)
    ds_read_b128 v[108:111], v151 offset:32768
    v_exp_f32 v53, v53
    v_add_f32 v168, v168, v50
    v_add_f32 v169, v169, v51
    v_cvt_pk_bf16_f32 v49, v50, v51
    s_waitcnt lgkmcnt(8)
    v_mfma_f32_32x32x16_bf16 a[0:15], v[128:131], v[20:23], a[0:15]
    v_exp_f32 v54, v54
    v_exp_f32 v55, v55
    v_add_f32 v168, v168, v52
    v_add_f32 v169, v169, v53
    v_mfma_f32_32x32x16_bf16 a[64:79], v[128:131], v[36:39], a[64:79]
    s_add_u32 m0, s44, 114688
    s_nop 0
    buffer_load_dwordx4 v184, s[12:15], s38 offen lds
    buffer_load_dwordx4 v185, s[12:15], s38 offen offset:1024 lds
    v_mfma_f32_32x32x16_bf16 a[16:31], v[132:135], v[20:23], a[16:31]
    v_cvt_pk_bf16_f32 v50, v52, v53
    v_exp_f32 v56, v56
    v_exp_f32 v57, v57
    v_add_f32 v168, v168, v54
    v_mfma_f32_32x32x16_bf16 a[80:95], v[132:135], v[36:39], a[80:95]
    v_add_f32 v169, v169, v55
    v_cvt_pk_bf16_f32 v51, v54, v55
    v_exp_f32 v58, v58
    v_exp_f32 v59, v59
    v_mfma_f32_32x32x16_bf16 a[32:47], v[136:139], v[20:23], a[32:47]
    v_add_f32 v168, v168, v56
    v_add_f32 v169, v169, v57
    v_cvt_pk_bf16_f32 v52, v56, v57
    v_exp_f32 v60, v60
    v_mfma_f32_32x32x16_bf16 a[96:111], v[136:139], v[36:39], a[96:111]
    s_add_u32 m0, s44, 122880
    s_nop 0
    buffer_load_dwordx4 v186, s[16:19], s38 offen lds
    buffer_load_dwordx4 v186, s[16:19], s38 offen offset:1024 lds
    s_add_u32 s38, s38, 8192
    v_mfma_f32_32x32x16_bf16 a[48:63], v[140:143], v[20:23], a[48:63]
    v_exp_f32 v61, v61
    v_add_f32 v168, v168, v58
    v_add_f32 v169, v169, v59
    v_cvt_pk_bf16_f32 v53, v58, v59
    v_mfma_f32_32x32x16_bf16 a[112:127], v[140:143], v[36:39], a[112:127]
    v_exp_f32 v62, v62
    v_exp_f32 v63, v63
    v_add_f32 v168, v168, v60
    v_add_f32 v169, v169, v61
    v_cvt_pk_bf16_f32 v54, v60, v61
    v_add_f32 v168, v168, v62
    s_waitcnt lgkmcnt(0)
    v_mfma_f32_32x32x16_bf16 v[16:31], v[80:83], a[128:131], v[192:207]
    ds_read_b64_tr_b16 v[112:113], v160 offset:24576
    v_add_f32 v169, v169, v63
    v_cvt_pk_bf16_f32 v55, v62, v63
    v_exp_f32 v64, v64
    v_mfma_f32_32x32x16_bf16 v[32:47], v[80:83], a[160:163], v[208:223]
    ds_read_b64_tr_b16 v[114:115], v160 offset:26624
    v_exp_f32 v65, v65
    v_exp_f32 v66, v66
    v_mfma_f32_32x32x16_bf16 v[16:31], v[84:87], a[132:135], v[16:31]
    ds_read_b64_tr_b16 v[116:117], v161 offset:24576
    v_exp_f32 v67, v67
    v_add_f32 v173, v173, v64
    v_add_f32 v174, v174, v65
    v_mfma_f32_32x32x16_bf16 v[32:47], v[84:87], a[164:167], v[32:47]
    ds_read_b64_tr_b16 v[118:119], v161 offset:26624
    v_cvt_pk_bf16_f32 v64, v64, v65
    v_exp_f32 v68, v68
    v_mfma_f32_32x32x16_bf16 v[16:31], v[88:91], a[136:139], v[16:31]
    ds_read_b64_tr_b16 v[120:121], v162 offset:24576
    v_exp_f32 v69, v69
    v_add_f32 v173, v173, v66
    v_add_f32 v174, v174, v67
    v_mfma_f32_32x32x16_bf16 v[32:47], v[88:91], a[168:171], v[32:47]
    ds_read_b64_tr_b16 v[122:123], v162 offset:26624
    v_cvt_pk_bf16_f32 v65, v66, v67
    v_exp_f32 v70, v70
    v_mfma_f32_32x32x16_bf16 v[16:31], v[92:95], a[140:143], v[16:31]
    ds_read_b64_tr_b16 v[124:125], v163 offset:24576
    v_exp_f32 v71, v71
    v_add_f32 v173, v173, v68
    v_add_f32 v174, v174, v69
    v_mfma_f32_32x32x16_bf16 v[32:47], v[92:95], a[172:175], v[32:47]
    ds_read_b64_tr_b16 v[126:127], v163 offset:26624
    v_cvt_pk_bf16_f32 v66, v68, v69
    v_exp_f32 v72, v72
    v_mfma_f32_32x32x16_bf16 v[16:31], v[96:99], a[144:147], v[16:31]
    ds_read_b64_tr_b16 v[128:129], v160 offset:28672
    v_exp_f32 v73, v73
    v_add_f32 v173, v173, v70
    v_add_f32 v174, v174, v71
    v_mfma_f32_32x32x16_bf16 v[32:47], v[96:99], a[176:179], v[32:47]
    ds_read_b64_tr_b16 v[130:131], v160 offset:30720
    v_cvt_pk_bf16_f32 v67, v70, v71
    v_exp_f32 v74, v74
    v_mfma_f32_32x32x16_bf16 v[16:31], v[100:103], a[148:151], v[16:31]
    ds_read_b64_tr_b16 v[132:133], v161 offset:28672
    v_exp_f32 v75, v75
    v_add_f32 v173, v173, v72
    v_add_f32 v174, v174, v73
    v_mfma_f32_32x32x16_bf16 v[32:47], v[100:103], a[180:183], v[32:47]
    ds_read_b64_tr_b16 v[134:135], v161 offset:30720
    v_cvt_pk_bf16_f32 v68, v72, v73
    v_exp_f32 v76, v76
    v_mfma_f32_32x32x16_bf16 v[16:31], v[104:107], a[152:155], v[16:31]
    ds_read_b64_tr_b16 v[136:137], v162 offset:28672
    v_exp_f32 v77, v77
    v_add_f32 v173, v173, v74
    v_add_f32 v174, v174, v75
    v_mfma_f32_32x32x16_bf16 v[32:47], v[104:107], a[184:187], v[32:47]
    ds_read_b64_tr_b16 v[138:139], v162 offset:30720
    v_cvt_pk_bf16_f32 v69, v74, v75
    v_exp_f32 v78, v78
    v_mfma_f32_32x32x16_bf16 v[16:31], v[108:111], a[156:159], v[16:31]
    ds_read_b64_tr_b16 v[140:141], v163 offset:28672
    v_exp_f32 v79, v79
    v_add_f32 v173, v173, v76
    v_add_f32 v174, v174, v77
    v_mfma_f32_32x32x16_bf16 v[32:47], v[108:111], a[188:191], v[32:47]
    s_waitcnt lgkmcnt(14)
    ds_read_b64_tr_b16 v[142:143], v163 offset:30720
    v_cvt_pk_bf16_f32 v70, v76, v77
    v_add_f32 v173, v173, v78
    v_add_f32 v174, v174, v79
    v_cvt_pk_bf16_f32 v71, v78, v79
    s_cmp_eq_u32 s39, 0
    s_cbranch_scc1 L_ap52
    s_call_b64 s[40:41], L_apply
L_ap52:
    s_waitcnt lgkmcnt(8)
    v_mfma_f32_32x32x16_bf16 a[0:15], v[112:115], v[48:51], a[0:15]
    ds_read_b128 v[80:83], v144 offset:49152
    v_max3_f32 v171, v16, v17, v18
    v_max3_f32 v172, v19, v20, v21
    v_max3_f32 v171, v171, v22, v23
    v_max3_f32 v172, v172, v24, v25
    v_max3_f32 v171, v171, v26, v27
    v_mfma_f32_32x32x16_bf16 a[64:79], v[112:115], v[64:67], a[64:79]
    ds_read_b128 v[84:87], v145 offset:49152
    v_max3_f32 v172, v172, v28, v29
    v_max3_f32 v171, v171, v30, v31
    v_max_f32 v171, v171, v172
    v_max3_f32 v176, v32, v33, v34
    v_max3_f32 v177, v35, v36, v37
    v_mfma_f32_32x32x16_bf16 a[16:31], v[116:119], v[48:51], a[16:31]
    ds_read_b128 v[88:91], v146 offset:49152
    v_max3_f32 v176, v176, v38, v39
    v_max3_f32 v177, v177, v40, v41
    v_max3_f32 v176, v176, v42, v43
    v_max3_f32 v177, v177, v44, v45
    v_max3_f32 v176, v176, v46, v47
    v_mfma_f32_32x32x16_bf16 a[80:95], v[116:119], v[64:67], a[80:95]
    ds_read_b128 v[92:95], v147 offset:49152
    v_max_f32 v176, v176, v177
    v_cmp_lt_f32 vcc, s37, v171
    s_cbranch_vccz L_sk50
    s_call_b64 s[40:41], L_rare00
L_sk50:
    v_cmp_lt_f32 vcc, s37, v176
    s_cbranch_vccz L_sk51
    s_call_b64 s[40:41], L_rare10
L_sk51:
    v_mfma_f32_32x32x16_bf16 a[32:47], v[120:123], v[48:51], a[32:47]
    ds_read_b128 v[96:99], v148 offset:49152
    v_exp_f32 v16, v16
    v_exp_f32 v17, v17
    v_mfma_f32_32x32x16_bf16 a[96:111], v[120:123], v[64:67], a[96:111]
    ds_read_b128 v[100:103], v149 offset:49152
    v_exp_f32 v18, v18
    v_exp_f32 v19, v19
    v_add_f32 v168, v168, v16
    v_mfma_f32_32x32x16_bf16 a[48:63], v[124:127], v[48:51], a[48:63]
    ds_read_b128 v[104:107], v150 offset:49152
    v_add_f32 v169, v169, v17
    v_cvt_pk_bf16_f32 v16, v16, v17
    v_exp_f32 v20, v20
    v_mfma_f32_32x32x16_bf16 a[112:127], v[124:127], v[64:67], a[112:127]
    s_waitcnt lgkmcnt(14)
    ds_read_b128 v[108:111], v151 offset:49152
    v_exp_f32 v21, v21
    v_add_f32 v168, v168, v18
    v_add_f32 v169, v169, v19
    v_cvt_pk_bf16_f32 v17, v18, v19
    s_waitcnt lgkmcnt(8)
    v_mfma_f32_32x32x16_bf16 a[0:15], v[128:131], v[52:55], a[0:15]
    v_exp_f32 v22, v22
    v_exp_f32 v23, v23
    v_add_f32 v168, v168, v20
    v_add_f32 v169, v169, v21
    v_mfma_f32_32x32x16_bf16 a[64:79], v[128:131], v[68:71], a[64:79]
    v_cvt_pk_bf16_f32 v18, v20, v21
    v_exp_f32 v24, v24
    v_exp_f32 v25, v25
    v_add_f32 v168, v168, v22
    v_mfma_f32_32x32x16_bf16 a[16:31], v[132:135], v[52:55], a[16:31]
    v_add_f32 v169, v169, v23
    v_cvt_pk_bf16_f32 v19, v22, v23
    v_exp_f32 v26, v26
    v_exp_f32 v27, v27
    v_mfma_f32_32x32x16_bf16 a[80:95], v[132:135], v[68:71], a[80:95]
    v_add_f32 v168, v168, v24
    v_add_f32 v169, v169, v25
    v_cvt_pk_bf16_f32 v20, v24, v25
    v_exp_f32 v28, v28
    v_mfma_f32_32x32x16_bf16 a[32:47], v[136:139], v[52:55], a[32:47]
    v_exp_f32 v29, v29
    v_add_f32 v168, v168, v26
    v_add_f32 v169, v169, v27
    v_cvt_pk_bf16_f32 v21, v26, v27
    v_mfma_f32_32x32x16_bf16 a[96:111], v[136:139], v[68:71], a[96:111]
    v_exp_f32 v30, v30
    v_exp_f32 v31, v31
    v_add_f32 v168, v168, v28
    v_add_f32 v169, v169, v29
    v_mfma_f32_32x32x16_bf16 a[48:63], v[140:143], v[52:55], a[48:63]
    v_cvt_pk_bf16_f32 v22, v28, v29
    v_add_f32 v168, v168, v30
    v_mfma_f32_32x32x16_bf16 a[112:127], v[140:143], v[68:71], a[112:127]
    s_waitcnt vmcnt(8)
    s_barrier
    s_waitcnt lgkmcnt(0)
    v_mfma_f32_32x32x16_bf16 v[48:63], v[80:83], a[128:131], v[192:207]
    ds_read_b64_tr_b16 v[112:113], v160 offset:40960
    v_add_f32 v169, v169, v31
    v_cvt_pk_bf16_f32 v23, v30, v31
    v_exp_f32 v32, v32
    v_mfma_f32_32x32x16_bf16 v[64:79], v[80:83], a[160:163], v[208:223]
    ds_read_b64_tr_b16 v[114:115], v160 offset:43008
    v_exp_f32 v33, v33
    v_exp_f32 v34, v34
    v_mfma_f32_32x32x16_bf16 v[48:63], v[84:87], a[132:135], v[48:63]
    ds_read_b64_tr_b16 v[116:117], v161 offset:40960
    v_exp_f32 v35, v35
    v_add_f32 v173, v173, v32
    v_add_f32 v174, v174, v33
    v_mfma_f32_32x32x16_bf16 v[64:79], v[84:87], a[164:167], v[64:79]
    ds_read_b64_tr_b16 v[118:119], v161 offset:43008
    v_cvt_pk_bf16_f32 v32, v32, v33
    v_exp_f32 v36, v36
    v_mfma_f32_32x32x16_bf16 v[48:63], v[88:91], a[136:139], v[48:63]
    ds_read_b64_tr_b16 v[120:121], v162 offset:40960
    v_exp_f32 v37, v37
    v_add_f32 v173, v173, v34
    v_add_f32 v174, v174, v35
    v_mfma_f32_32x32x16_bf16 v[64:79], v[88:91], a[168:171], v[64:79]
    ds_read_b64_tr_b16 v[122:123], v162 offset:43008
    v_cvt_pk_bf16_f32 v33, v34, v35
    v_exp_f32 v38, v38
    v_mfma_f32_32x32x16_bf16 v[48:63], v[92:95], a[140:143], v[48:63]
    ds_read_b64_tr_b16 v[124:125], v163 offset:40960
    v_exp_f32 v39, v39
    v_add_f32 v173, v173, v36
    v_add_f32 v174, v174, v37
    v_mfma_f32_32x32x16_bf16 v[64:79], v[92:95], a[172:175], v[64:79]
    ds_read_b64_tr_b16 v[126:127], v163 offset:43008
    v_cvt_pk_bf16_f32 v34, v36, v37
    v_exp_f32 v40, v40
    v_mfma_f32_32x32x16_bf16 v[48:63], v[96:99], a[144:147], v[48:63]
    ds_read_b64_tr_b16 v[128:129], v160 offset:45056
    v_exp_f32 v41, v41
    v_add_f32 v173, v173, v38
    v_add_f32 v174, v174, v39
    v_mfma_f32_32x32x16_bf16 v[64:79], v[96:99], a[176:179], v[64:79]
    ds_read_b64_tr_b16 v[130:131], v160 offset:47104
    v_cvt_pk_bf16_f32 v35, v38, v39
    v_exp_f32 v42, v42
    v_mfma_f32_32x32x16_bf16 v[48:63], v[100:103], a[148:151], v[48:63]
    ds_read_b64_tr_b16 v[132:133], v161 offset:45056
    v_exp_f32 v43, v43
    v_add_f32 v173, v173, v40
    v_add_f32 v174, v174, v41
    v_mfma_f32_32x32x16_bf16 v[64:79], v[100:103], a[180:183], v[64:79]
    ds_read_b64_tr_b16 v[134:135], v161 offset:47104
    v_cvt_pk_bf16_f32 v36, v40, v41
    v_exp_f32 v44, v44
    v_mfma_f32_32x32x16_bf16 v[48:63], v[104:107], a[152:155], v[48:63]
    ds_read_b64_tr_b16 v[136:137], v162 offset:45056
    v_exp_f32 v45, v45
    v_add_f32 v173, v173, v42
    v_add_f32 v174, v174, v43
    v_mfma_f32_32x32x16_bf16 v[64:79], v[104:107], a[184:187], v[64:79]
    ds_read_b64_tr_b16 v[138:139], v162 offset:47104
    v_cvt_pk_bf16_f32 v37, v42, v43
    v_exp_f32 v46, v46
    v_mfma_f32_32x32x16_bf16 v[48:63], v[108:111], a[156:159], v[48:63]
    ds_read_b64_tr_b16 v[140:141], v163 offset:45056
    v_exp_f32 v47, v47
    v_add_f32 v173, v173, v44
    v_add_f32 v174, v174, v45
    v_mfma_f32_32x32x16_bf16 v[64:79], v[108:111], a[188:191], v[64:79]
    s_waitcnt lgkmcnt(14)
    ds_read_b64_tr_b16 v[142:143], v163 offset:47104
    v_cvt_pk_bf16_f32 v38, v44, v45
    v_add_f32 v173, v173, v46
    v_add_f32 v174, v174, v47
    v_cvt_pk_bf16_f32 v39, v46, v47
    s_cmp_eq_u32 s39, 0
    s_cbranch_scc1 L_ap57
    s_call_b64 s[40:41], L_apply
L_ap57:
    s_waitcnt lgkmcnt(8)
    v_mfma_f32_32x32x16_bf16 a[0:15], v[112:115], v[16:19], a[0:15]
    ds_read_b128 v[80:83], v152 offset:0
    v_max3_f32 v171, v48, v49, v50
    v_max3_f32 v172, v51, v52, v53
    v_max3_f32 v171, v171, v54, v55
    v_max3_f32 v172, v172, v56, v57
    v_max3_f32 v171, v171, v58, v59
    v_mfma_f32_32x32x16_bf16 a[64:79], v[112:115], v[32:35], a[64:79]
    ds_read_b128 v[84:87], v153 offset:0
    v_max3_f32 v172, v172, v60, v61
    v_max3_f32 v171, v171, v62, v63
    v_max_f32 v171, v171, v172
    v_max3_f32 v176, v64, v65, v66
    v_max3_f32 v177, v67, v68, v69
    v_mfma_f32_32x32x16_bf16 a[16:31], v[116:119], v[16:19], a[16:31]
    ds_read_b128 v[88:91], v154 offset:0
    v_max3_f32 v176, v176, v70, v71
    v_max3_f32 v177, v177, v72, v73
    v_max3_f32 v176, v176, v74, v75
    v_max3_f32 v177, v177, v76, v77
    v_max3_f32 v176, v176, v78, v79
    v_mfma_f32_32x32x16_bf16 a[80:95], v[116:119], v[32:35], a[80:95]
    ds_read_b128 v[92:95], v155 offset:0
    v_max_f32 v176, v176, v177
    v_cmp_lt_f32 vcc, s37, v171
    s_cbranch_vccz L_sk55
    s_call_b64 s[40:41], L_rare01
L_sk55:
    v_cmp_lt_f32 vcc, s37, v176
    s_cbranch_vccz L_sk56
    s_call_b64 s[40:41], L_rare11
L_sk56:
    v_mfma_f32_32x32x16_bf16 a[32:47], v[120:123], v[16:19], a[32:47]
    ds_read_b128 v[96:99], v156 offset:0
    v_exp_f32 v48, v48
    v_exp_f32 v49, v49
    v_mfma_f32_32x32x16_bf16 a[96:111], v[120:123], v[32:35], a[96:111]
    ds_read_b128 v[100:103], v157 offset:0
    v_exp_f32 v50, v50
    v_exp_f32 v51, v51
    v_add_f32 v168, v168, v48
    v_mfma_f32_32x32x16_bf16 a[48:63], v[124:127], v[16:19], a[48:63]
    ds_read_b128 v[104:107], v158 offset:0
    v_add_f32 v169, v169, v49
    v_cvt_pk_bf16_f32 v48, v48, v49
    v_exp_f32 v52, v52
    v_mfma_f32_32x32x16_bf16 a[112:127], v[124:127], v[32:35], a[112:127]
    s_waitcnt lgkmcnt(14)
    ds_read_b128 v[108:111], v159 offset:0
    v_exp_f32 v53, v53
    v_add_f32 v168, v168, v50
    v_add_f32 v169, v169, v51
    v_cvt_pk_bf16_f32 v49, v50, v51
    s_waitcnt lgkmcnt(8)
    v_mfma_f32_32x32x16_bf16 a[0:15], v[128:131], v[20:23], a[0:15]
    v_exp_f32 v54, v54
    v_exp_f32 v55, v55
    v_add_f32 v168, v168, v52
    v_add_f32 v169, v169, v53
    v_mfma_f32_32x32x16_bf16 a[64:79], v[128:131], v[36:39], a[64:79]
    v_cvt_pk_bf16_f32 v50, v52, v53
    v_exp_f32 v56, v56
    v_exp_f32 v57, v57
    v_add_f32 v168, v168, v54
    v_mfma_f32_32x32x16_bf16 a[16:31], v[132:135], v[20:23], a[16:31]
    v_add_f32 v169, v169, v55
    v_cvt_pk_bf16_f32 v51, v54, v55
    v_exp_f32 v58, v58
    v_exp_f32 v59, v59
    v_mfma_f32_32x32x16_bf16 a[80:95], v[132:135], v[36:39], a[80:95]
    v_add_f32 v168, v168, v56
    v_add_f32 v169, v169, v57
    v_cvt_pk_bf16_f32 v52, v56, v57
    v_exp_f32 v60, v60
    v_mfma_f32_32x32x16_bf16 a[32:47], v[136:139], v[20:23], a[32:47]
    v_exp_f32 v61, v61
    v_add_f32 v168, v168, v58
    v_add_f32 v169, v169, v59
    v_cvt_pk_bf16_f32 v53, v58, v59
    v_mfma_f32_32x32x16_bf16 a[96:111], v[136:139], v[36:39], a[96:111]
    v_exp_f32 v62, v62
    v_exp_f32 v63, v63
    v_add_f32 v168, v168, v60
    v_add_f32 v169, v169, v61
    v_mfma_f32_32x32x16_bf16 a[48:63], v[140:143], v[20:23], a[48:63]
    v_cvt_pk_bf16_f32 v54, v60, v61
    v_add_f32 v168, v168, v62
    v_mfma_f32_32x32x16_bf16 a[112:127], v[140:143], v[36:39], a[112:127]
    s_waitcnt lgkmcnt(0)
    v_mfma_f32_32x32x16_bf16 v[16:31], v[80:83], a[128:131], v[192:207]
    ds_read_b64_tr_b16 v[112:113], v160 offset:57344
    v_add_f32 v169, v169, v63
    v_cvt_pk_bf16_f32 v55, v62, v63
    v_exp_f32 v64, v64
    v_mfma_f32_32x32x16_bf16 v[32:47], v[80:83], a[160:163], v[208:223]
    ds_read_b64_tr_b16 v[114:115], v160 offset:59392
    v_exp_f32 v65, v65
    v_exp_f32 v66, v66
    v_mfma_f32_32x32x16_bf16 v[16:31], v[84:87], a[132:135], v[16:31]
    ds_read_b64_tr_b16 v[116:117], v161 offset:57344
    v_exp_f32 v67, v67
    v_add_f32 v173, v173, v64
    v_add_f32 v174, v174, v65
    v_mfma_f32_32x32x16_bf16 v[32:47], v[84:87], a[164:167], v[32:47]
    ds_read_b64_tr_b16 v[118:119], v161 offset:59392
    v_cvt_pk_bf16_f32 v64, v64, v65
    v_exp_f32 v68, v68
    v_mfma_f32_32x32x16_bf16 v[16:31], v[88:91], a[136:139], v[16:31]
    ds_read_b64_tr_b16 v[120:121], v162 offset:57344
    v_exp_f32 v69, v69
    v_add_f32 v173, v173, v66
    v_add_f32 v174, v174, v67
    v_mfma_f32_32x32x16_bf16 v[32:47], v[88:91], a[168:171], v[32:47]
    ds_read_b64_tr_b16 v[122:123], v162 offset:59392
    v_cvt_pk_bf16_f32 v65, v66, v67
    v_exp_f32 v70, v70
    v_mfma_f32_32x32x16_bf16 v[16:31], v[92:95], a[140:143], v[16:31]
    ds_read_b64_tr_b16 v[124:125], v163 offset:57344
    v_exp_f32 v71, v71
    v_add_f32 v173, v173, v68
    v_add_f32 v174, v174, v69
    v_mfma_f32_32x32x16_bf16 v[32:47], v[92:95], a[172:175], v[32:47]
    ds_read_b64_tr_b16 v[126:127], v163 offset:59392
    v_cvt_pk_bf16_f32 v66, v68, v69
    v_exp_f32 v72, v72
    v_mfma_f32_32x32x16_bf16 v[16:31], v[96:99], a[144:147], v[16:31]
    ds_read_b64_tr_b16 v[128:129], v160 offset:61440
    v_exp_f32 v73, v73
    v_add_f32 v173, v173, v70
    v_add_f32 v174, v174, v71
    v_mfma_f32_32x32x16_bf16 v[32:47], v[96:99], a[176:179], v[32:47]
    ds_read_b64_tr_b16 v[130:131], v160 offset:63488
    v_cvt_pk_bf16_f32 v67, v70, v71
    v_exp_f32 v74, v74
    v_mfma_f32_32x32x16_bf16 v[16:31], v[100:103], a[148:151], v[16:31]
    ds_read_b64_tr_b16 v[132:133], v161 offset:61440
    v_exp_f32 v75, v75
    v_add_f32 v173, v173, v72
    v_add_f32 v174, v174, v73
    v_mfma_f32_32x32x16_bf16 v[32:47], v[100:103], a[180:183], v[32:47]
    ds_read_b64_tr_b16 v[134:135], v161 offset:63488
    v_cvt_pk_bf16_f32 v68, v72, v73
    v_exp_f32 v76, v76
    v_mfma_f32_32x32x16_bf16 v[16:31], v[104:107], a[152:155], v[16:31]
    ds_read_b64_tr_b16 v[136:137], v162 offset:61440
    v_exp_f32 v77, v77
    v_add_f32 v173, v173, v74
    v_add_f32 v174, v174, v75
    v_mfma_f32_32x32x16_bf16 v[32:47], v[104:107], a[184:187], v[32:47]
    ds_read_b64_tr_b16 v[138:139], v162 offset:63488
    v_cvt_pk_bf16_f32 v69, v74, v75
    v_exp_f32 v78, v78
    v_mfma_f32_32x32x16_bf16 v[16:31], v[108:111], a[156:159], v[16:31]
    ds_read_b64_tr_b16 v[140:141], v163 offset:61440
    v_exp_f32 v79, v79
    v_add_f32 v173, v173, v76
    v_add_f32 v174, v174, v77
    v_mfma_f32_32x32x16_bf16 v[32:47], v[108:111], a[188:191], v[32:47]
    s_waitcnt lgkmcnt(14)
    ds_read_b64_tr_b16 v[142:143], v163 offset:63488
    v_cvt_pk_bf16_f32 v70, v76, v77
    v_add_f32 v173, v173, v78
    v_add_f32 v174, v174, v79
    v_cvt_pk_bf16_f32 v71, v78, v79
    s_cmp_eq_u32 s39, 0
    s_cbranch_scc1 L_ap62
    s_call_b64 s[40:41], L_apply
L_ap62:
    s_waitcnt lgkmcnt(8)
    v_mfma_f32_32x32x16_bf16 a[0:15], v[112:115], v[48:51], a[0:15]
    ds_read_b128 v[80:83], v152 offset:16384
    v_max3_f32 v171, v16, v17, v18
    v_max3_f32 v172, v19, v20, v21
    v_max3_f32 v171, v171, v22, v23
    v_max3_f32 v172, v172, v24, v25
    v_max3_f32 v171, v171, v26, v27
    v_mfma_f32_32x32x16_bf16 a[64:79], v[112:115], v[64:67], a[64:79]
    ds_read_b128 v[84:87], v153 offset:16384
    v_max3_f32 v172, v172, v28, v29
    v_max3_f32 v171, v171, v30, v31
    v_max_f32 v171, v171, v172
    v_max3_f32 v176, v32, v33, v34
    v_max3_f32 v177, v35, v36, v37
    v_mfma_f32_32x32x16_bf16 a[16:31], v[116:119], v[48:51], a[16:31]
    ds_read_b128 v[88:91], v154 offset:16384
    v_max3_f32 v176, v176, v38, v39
    v_max3_f32 v177, v177, v40, v41
    v_max3_f32 v176, v176, v42, v43
    v_max3_f32 v177, v177, v44, v45
    v_max3_f32 v176, v176, v46, v47
    v_mfma_f32_32x32x16_bf16 a[80:95], v[116:119], v[64:67], a[80:95]
    ds_read_b128 v[92:95], v155 offset:16384
    v_max_f32 v176, v176, v177
    v_cmp_lt_f32 vcc, s37, v171
    s_cbranch_vccz L_sk60
    s_call_b64 s[40:41], L_rare00
L_sk60:
    v_cmp_lt_f32 vcc, s37, v176
    s_cbranch_vccz L_sk61
    s_call_b64 s[40:41], L_rare10
L_sk61:
    v_mfma_f32_32x32x16_bf16 a[32:47], v[120:123], v[48:51], a[32:47]
    ds_read_b128 v[96:99], v156 offset:16384
    v_exp_f32 v16, v16
    v_exp_f32 v17, v17
    v_mfma_f32_32x32x16_bf16 a[96:111], v[120:123], v[64:67], a[96:111]
    ds_read_b128 v[100:103], v157 offset:16384
    v_exp_f32 v18, v18
    v_exp_f32 v19, v19
    v_add_f32 v168, v168, v16
    v_mfma_f32_32x32x16_bf16 a[48:63], v[124:127], v[48:51], a[48:63]
    ds_read_b128 v[104:107], v158 offset:16384
    v_add_f32 v169, v169, v17
    v_cvt_pk_bf16_f32 v16, v16, v17
    v_exp_f32 v20, v20
    v_mfma_f32_32x32x16_bf16 a[112:127], v[124:127], v[64:67], a[112:127]
    s_waitcnt lgkmcnt(14)
    ds_read_b128 v[108:111], v159 offset:16384
    v_exp_f32 v21, v21
    v_add_f32 v168, v168, v18
    v_add_f32 v169, v169, v19
    v_cvt_pk_bf16_f32 v17, v18, v19
    s_waitcnt lgkmcnt(8)
    v_mfma_f32_32x32x16_bf16 a[0:15], v[128:131], v[52:55], a[0:15]
    v_exp_f32 v22, v22
    v_exp_f32 v23, v23
    v_add_f32 v168, v168, v20
    v_add_f32 v169, v169, v21
    v_mfma_f32_32x32x16_bf16 a[64:79], v[128:131], v[68:71], a[64:79]
    v_cvt_pk_bf16_f32 v18, v20, v21
    v_exp_f32 v24, v24
    v_exp_f32 v25, v25
    v_add_f32 v168, v168, v22
    v_mfma_f32_32x32x16_bf16 a[16:31], v[132:135], v[52:55], a[16:31]
    v_add_f32 v169, v169, v23
    v_cvt_pk_bf16_f32 v19, v22, v23
    v_exp_f32 v26, v26
    v_exp_f32 v27, v27
    v_mfma_f32_32x32x16_bf16 a[80:95], v[132:135], v[68:71], a[80:95]
    v_add_f32 v168, v168, v24
    v_add_f32 v169, v169, v25
    v_cvt_pk_bf16_f32 v20, v24, v25
    v_exp_f32 v28, v28
    v_mfma_f32_32x32x16_bf16 a[32:47], v[136:139], v[52:55], a[32:47]
    v_exp_f32 v29, v29
    v_add_f32 v168, v168, v26
    v_add_f32 v169, v169, v27
    v_cvt_pk_bf16_f32 v21, v26, v27
    v_mfma_f32_32x32x16_bf16 a[96:111], v[136:139], v[68:71], a[96:111]
    v_exp_f32 v30, v30
    v_exp_f32 v31, v31
    v_add_f32 v168, v168, v28
    v_add_f32 v169, v169, v29
    v_mfma_f32_32x32x16_bf16 a[48:63], v[140:143], v[52:55], a[48:63]
    v_cvt_pk_bf16_f32 v22, v28, v29
    v_add_f32 v168, v168, v30
    v_mfma_f32_32x32x16_bf16 a[112:127], v[140:143], v[68:71], a[112:127]
    s_waitcnt vmcnt(0)
    s_barrier
    s_waitcnt lgkmcnt(0)
    v_mfma_f32_32x32x16_bf16 v[48:63], v[80:83], a[128:131], v[192:207]
    ds_read_b64_tr_b16 v[112:113], v164 offset:8192
    v_add_f32 v169, v169, v31
    v_cvt_pk_bf16_f32 v23, v30, v31
    v_exp_f32 v32, v32
    v_mfma_f32_32x32x16_bf16 v[64:79], v[80:83], a[160:163], v[208:223]
    ds_read_b64_tr_b16 v[114:115], v164 offset:10240
    v_exp_f32 v33, v33
    v_exp_f32 v34, v34
    v_mfma_f32_32x32x16_bf16 v[48:63], v[84:87], a[132:135], v[48:63]
    ds_read_b64_tr_b16 v[116:117], v165 offset:8192
    v_exp_f32 v35, v35
    v_add_f32 v173, v173, v32
    v_add_f32 v174, v174, v33
    v_mfma_f32_32x32x16_bf16 v[64:79], v[84:87], a[164:167], v[64:79]
    ds_read_b64_tr_b16 v[118:119], v165 offset:10240
    v_cvt_pk_bf16_f32 v32, v32, v33
    v_exp_f32 v36, v36
    v_mfma_f32_32x32x16_bf16 v[48:63], v[88:91], a[136:139], v[48:63]
    ds_read_b64_tr_b16 v[120:121], v166 offset:8192
    v_exp_f32 v37, v37
    v_add_f32 v173, v173, v34
    v_add_f32 v174, v174, v35
    v_mfma_f32_32x32x16_bf16 v[64:79], v[88:91], a[168:171], v[64:79]
    ds_read_b64_tr_b16 v[122:123], v166 offset:10240
    v_cvt_pk_bf16_f32 v33, v34, v35
    v_exp_f32 v38, v38
    v_mfma_f32_32x32x16_bf16 v[48:63], v[92:95], a[140:143], v[48:63]
    ds_read_b64_tr_b16 v[124:125], v167 offset:8192
    v_exp_f32 v39, v39
    v_add_f32 v173, v173, v36
    v_add_f32 v174, v174, v37
    v_mfma_f32_32x32x16_bf16 v[64:79], v[92:95], a[172:175], v[64:79]
    ds_read_b64_tr_b16 v[126:127], v167 offset:10240
    v_cvt_pk_bf16_f32 v34, v36, v37
    v_exp_f32 v40, v40
    v_mfma_f32_32x32x16_bf16 v[48:63], v[96:99], a[144:147], v[48:63]
    ds_read_b64_tr_b16 v[128:129], v164 offset:12288
    v_exp_f32 v41, v41
    v_add_f32 v173, v173, v38
    v_add_f32 v174, v174, v39
    v_mfma_f32_32x32x16_bf16 v[64:79], v[96:99], a[176:179], v[64:79]
    ds_read_b64_tr_b16 v[130:131], v164 offset:14336
    v_cvt_pk_bf16_f32 v35, v38, v39
    v_exp_f32 v42, v42
    v_mfma_f32_32x32x16_bf16 v[48:63], v[100:103], a[148:151], v[48:63]
    ds_read_b64_tr_b16 v[132:133], v165 offset:12288
    v_exp_f32 v43, v43
    v_add_f32 v173, v173, v40
    v_add_f32 v174, v174, v41
    v_mfma_f32_32x32x16_bf16 v[64:79], v[100:103], a[180:183], v[64:79]
    ds_read_b64_tr_b16 v[134:135], v165 offset:14336
    v_cvt_pk_bf16_f32 v36, v40, v41
    v_exp_f32 v44, v44
    v_mfma_f32_32x32x16_bf16 v[48:63], v[104:107], a[152:155], v[48:63]
    ds_read_b64_tr_b16 v[136:137], v166 offset:12288
    v_exp_f32 v45, v45
    v_add_f32 v173, v173, v42
    v_add_f32 v174, v174, v43
    v_mfma_f32_32x32x16_bf16 v[64:79], v[104:107], a[184:187], v[64:79]
    ds_read_b64_tr_b16 v[138:139], v166 offset:14336
    v_cvt_pk_bf16_f32 v37, v42, v43
    v_exp_f32 v46, v46
    v_mfma_f32_32x32x16_bf16 v[48:63], v[108:111], a[156:159], v[48:63]
    ds_read_b64_tr_b16 v[140:141], v167 offset:12288
    v_exp_f32 v47, v47
    v_add_f32 v173, v173, v44
    v_add_f32 v174, v174, v45
    v_mfma_f32_32x32x16_bf16 v[64:79], v[108:111], a[188:191], v[64:79]
    s_waitcnt lgkmcnt(14)
    ds_read_b64_tr_b16 v[142:143], v167 offset:14336
    v_cvt_pk_bf16_f32 v38, v44, v45
    v_add_f32 v173, v173, v46
    v_add_f32 v174, v174, v47
    v_cvt_pk_bf16_f32 v39, v46, v47
    s_cmp_eq_u32 s39, 0
    s_cbranch_scc1 L_ap67
    s_call_b64 s[40:41], L_apply
L_ap67:
    s_waitcnt lgkmcnt(8)
    v_mfma_f32_32x32x16_bf16 a[0:15], v[112:115], v[16:19], a[0:15]
    ds_read_b128 v[80:83], v152 offset:32768
    v_max3_f32 v171, v48, v49, v50
    v_max3_f32 v172, v51, v52, v53
    v_max3_f32 v171, v171, v54, v55
    v_max3_f32 v172, v172, v56, v57
    v_max3_f32 v171, v171, v58, v59
    v_mfma_f32_32x32x16_bf16 a[64:79], v[112:115], v[32:35], a[64:79]
    ds_read_b128 v[84:87], v153 offset:32768
    v_max3_f32 v172, v172, v60, v61
    v_max3_f32 v171, v171, v62, v63
    v_max_f32 v171, v171, v172
    v_max3_f32 v176, v64, v65, v66
    v_max3_f32 v177, v67, v68, v69
    v_mfma_f32_32x32x16_bf16 a[16:31], v[116:119], v[16:19], a[16:31]
    ds_read_b128 v[88:91], v154 offset:32768
    v_max3_f32 v176, v176, v70, v71
    v_max3_f32 v177, v177, v72, v73
    v_max3_f32 v176, v176, v74, v75
    v_max3_f32 v177, v177, v76, v77
    v_max3_f32 v176, v176, v78, v79
    v_mfma_f32_32x32x16_bf16 a[80:95], v[116:119], v[32:35], a[80:95]
    ds_read_b128 v[92:95], v155 offset:32768
    v_max_f32 v176, v176, v177
    v_cmp_lt_f32 vcc, s37, v171
    s_cbranch_vccz L_sk65
    s_call_b64 s[40:41], L_rare01
L_sk65:
    v_cmp_lt_f32 vcc, s37, v176
    s_cbranch_vccz L_sk66
    s_call_b64 s[40:41], L_rare11
L_sk66:
    v_mfma_f32_32x32x16_bf16 a[32:47], v[120:123], v[16:19], a[32:47]
    ds_read_b128 v[96:99], v156 offset:32768
    v_exp_f32 v48, v48
    v_exp_f32 v49, v49
    v_mfma_f32_32x32x16_bf16 a[96:111], v[120:123], v[32:35], a[96:111]
    ds_read_b128 v[100:103], v157 offset:32768
    v_exp_f32 v50, v50
    v_exp_f32 v51, v51
    v_add_f32 v168, v168, v48
    v_mfma_f32_32x32x16_bf16 a[48:63], v[124:127], v[16:19], a[48:63]
    ds_read_b128 v[104:107], v158 offset:32768
    v_add_f32 v169, v169, v49
    v_cvt_pk_bf16_f32 v48, v48, v49
    v_exp_f32 v52, v52
    v_mfma_f32_32x32x16_bf16 a[112:127], v[124:127], v[32:35], a[112:127]
    s_waitcnt lgkmcnt(14)
    ds_read_b128 v[108:111], v159 offset:32768
    v_exp_f32 v53, v53
    v_add_f32 v168, v168, v50
    v_add_f32 v169, v169, v51
    v_cvt_pk_bf16_f32 v49, v50, v51
    s_waitcnt lgkmcnt(8)
    v_mfma_f32_32x32x16_bf16 a[0:15], v[128:131], v[20:23], a[0:15]
    v_exp_f32 v54, v54
    v_exp_f32 v55, v55
    v_add_f32 v168, v168, v52
    v_add_f32 v169, v169, v53
    v_mfma_f32_32x32x16_bf16 a[64:79], v[128:131], v[36:39], a[64:79]
    v_cvt_pk_bf16_f32 v50, v52, v53
    v_exp_f32 v56, v56
    v_exp_f32 v57, v57
    v_add_f32 v168, v168, v54
    v_mfma_f32_32x32x16_bf16 a[16:31], v[132:135], v[20:23], a[16:31]
    v_add_f32 v169, v169, v55
    v_cvt_pk_bf16_f32 v51, v54, v55
    v_exp_f32 v58, v58
    v_exp_f32 v59, v59
    v_mfma_f32_32x32x16_bf16 a[80:95], v[132:135], v[36:39], a[80:95]
    v_add_f32 v168, v168, v56
    v_add_f32 v169, v169, v57
    v_cvt_pk_bf16_f32 v52, v56, v57
    v_exp_f32 v60, v60
    v_mfma_f32_32x32x16_bf16 a[32:47], v[136:139], v[20:23], a[32:47]
    v_exp_f32 v61, v61
    v_add_f32 v168, v168, v58
    v_add_f32 v169, v169, v59
    v_cvt_pk_bf16_f32 v53, v58, v59
    v_mfma_f32_32x32x16_bf16 a[96:111], v[136:139], v[36:39], a[96:111]
    v_exp_f32 v62, v62
    v_exp_f32 v63, v63
    v_add_f32 v168, v168, v60
    v_add_f32 v169, v169, v61
    v_mfma_f32_32x32x16_bf16 a[48:63], v[140:143], v[20:23], a[48:63]
    v_cvt_pk_bf16_f32 v54, v60, v61
    v_add_f32 v168, v168, v62
    v_mfma_f32_32x32x16_bf16 a[112:127], v[140:143], v[36:39], a[112:127]
    s_waitcnt lgkmcnt(0)
    v_mfma_f32_32x32x16_bf16 v[16:31], v[80:83], a[128:131], v[192:207]
    ds_read_b64_tr_b16 v[112:113], v164 offset:24576
    v_add_f32 v169, v169, v63
    v_cvt_pk_bf16_f32 v55, v62, v63
    v_exp_f32 v64, v64
    v_mfma_f32_32x32x16_bf16 v[32:47], v[80:83], a[160:163], v[208:223]
    ds_read_b64_tr_b16 v[114:115], v164 offset:26624
    v_exp_f32 v65, v65
    v_exp_f32 v66, v66
    v_mfma_f32_32x32x16_bf16 v[16:31], v[84:87], a[132:135], v[16:31]
    ds_read_b64_tr_b16 v[116:117], v165 offset:24576
    v_exp_f32 v67, v67
    v_add_f32 v173, v173, v64
    v_add_f32 v174, v174, v65
    v_mfma_f32_32x32x16_bf16 v[32:47], v[84:87], a[164:167], v[32:47]
    ds_read_b64_tr_b16 v[118:119], v165 offset:26624
    v_cvt_pk_bf16_f32 v64, v64, v65
    v_exp_f32 v68, v68
    v_mfma_f32_32x32x16_bf16 v[16:31], v[88:91], a[136:139], v[16:31]
    ds_read_b64_tr_b16 v[120:121], v166 offset:24576
    v_exp_f32 v69, v69
    v_add_f32 v173, v173, v66
    v_add_f32 v174, v174, v67
    v_mfma_f32_32x32x16_bf16 v[32:47], v[88:91], a[168:171], v[32:47]
    ds_read_b64_tr_b16 v[122:123], v166 offset:26624
    v_cvt_pk_bf16_f32 v65, v66, v67
    v_exp_f32 v70, v70
    v_mfma_f32_32x32x16_bf16 v[16:31], v[92:95], a[140:143], v[16:31]
    ds_read_b64_tr_b16 v[124:125], v167 offset:24576
    v_exp_f32 v71, v71
    v_add_f32 v173, v173, v68
    v_add_f32 v174, v174, v69
    v_mfma_f32_32x32x16_bf16 v[32:47], v[92:95], a[172:175], v[32:47]
    ds_read_b64_tr_b16 v[126:127], v167 offset:26624
    v_cvt_pk_bf16_f32 v66, v68, v69
    v_exp_f32 v72, v72
    v_mfma_f32_32x32x16_bf16 v[16:31], v[96:99], a[144:147], v[16:31]
    ds_read_b64_tr_b16 v[128:129], v164 offset:28672
    v_exp_f32 v73, v73
    v_add_f32 v173, v173, v70
    v_add_f32 v174, v174, v71
    v_mfma_f32_32x32x16_bf16 v[32:47], v[96:99], a[176:179], v[32:47]
    ds_read_b64_tr_b16 v[130:131], v164 offset:30720
    v_cvt_pk_bf16_f32 v67, v70, v71
    v_exp_f32 v74, v74
    v_mfma_f32_32x32x16_bf16 v[16:31], v[100:103], a[148:151], v[16:31]
    ds_read_b64_tr_b16 v[132:133], v165 offset:28672
    v_exp_f32 v75, v75
    v_add_f32 v173, v173, v72
    v_add_f32 v174, v174, v73
    v_mfma_f32_32x32x16_bf16 v[32:47], v[100:103], a[180:183], v[32:47]
    ds_read_b64_tr_b16 v[134:135], v165 offset:30720
    v_cvt_pk_bf16_f32 v68, v72, v73
    v_exp_f32 v76, v76
    v_mfma_f32_32x32x16_bf16 v[16:31], v[104:107], a[152:155], v[16:31]
    ds_read_b64_tr_b16 v[136:137], v166 offset:28672
    v_exp_f32 v77, v77
    v_add_f32 v173, v173, v74
    v_add_f32 v174, v174, v75
    v_mfma_f32_32x32x16_bf16 v[32:47], v[104:107], a[184:187], v[32:47]
    ds_read_b64_tr_b16 v[138:139], v166 offset:30720
    v_cvt_pk_bf16_f32 v69, v74, v75
    v_exp_f32 v78, v78
    v_mfma_f32_32x32x16_bf16 v[16:31], v[108:111], a[156:159], v[16:31]
    ds_read_b64_tr_b16 v[140:141], v167 offset:28672
    v_exp_f32 v79, v79
    v_add_f32 v173, v173, v76
    v_add_f32 v174, v174, v77
    v_mfma_f32_32x32x16_bf16 v[32:47], v[108:111], a[188:191], v[32:47]
    s_waitcnt lgkmcnt(14)
    ds_read_b64_tr_b16 v[142:143], v167 offset:30720
    v_cvt_pk_bf16_f32 v70, v76, v77
    v_add_f32 v173, v173, v78
    v_add_f32 v174, v174, v79
    v_cvt_pk_bf16_f32 v71, v78, v79
    s_cmp_eq_u32 s39, 0
    s_cbranch_scc1 L_ap72
    s_call_b64 s[40:41], L_apply
L_ap72:
    s_waitcnt lgkmcnt(8)
    v_mfma_f32_32x32x16_bf16 a[0:15], v[112:115], v[48:51], a[0:15]
    ds_read_b128 v[80:83], v152 offset:49152
    v_max3_f32 v171, v16, v17, v18
    v_max3_f32 v172, v19, v20, v21
    v_max3_f32 v171, v171, v22, v23
    v_max3_f32 v172, v172, v24, v25
    v_max3_f32 v171, v171, v26, v27
    v_mfma_f32_32x32x16_bf16 a[64:79], v[112:115], v[64:67], a[64:79]
    ds_read_b128 v[84:87], v153 offset:49152
    v_max3_f32 v172, v172, v28, v29
    v_max3_f32 v171, v171, v30, v31
    v_max_f32 v171, v171, v172
    v_max3_f32 v176, v32, v33, v34
    v_max3_f32 v177, v35, v36, v37
    v_mfma_f32_32x32x16_bf16 a[16:31], v[116:119], v[48:51], a[16:31]
    ds_read_b128 v[88:91], v154 offset:49152
    v_max3_f32 v176, v176, v38, v39
    v_max3_f32 v177, v177, v40, v41
    v_max3_f32 v176, v176, v42, v43
    v_max3_f32 v177, v177, v44, v45
    v_max3_f32 v176, v176, v46, v47
    v_mfma_f32_32x32x16_bf16 a[80:95], v[116:119], v[64:67], a[80:95]
    ds_read_b128 v[92:95], v155 offset:49152
    v_max_f32 v176, v176, v177
    v_cmp_lt_f32 vcc, s37, v171
    s_cbranch_vccz L_sk70
    s_call_b64 s[40:41], L_rare00
L_sk70:
    v_cmp_lt_f32 vcc, s37, v176
    s_cbranch_vccz L_sk71
    s_call_b64 s[40:41], L_rare10
L_sk71:
    v_mfma_f32_32x32x16_bf16 a[32:47], v[120:123], v[48:51], a[32:47]
    ds_read_b128 v[96:99], v156 offset:49152
    v_exp_f32 v16, v16
    v_exp_f32 v17, v17
    v_mfma_f32_32x32x16_bf16 a[96:111], v[120:123], v[64:67], a[96:111]
    ds_read_b128 v[100:103], v157 offset:49152
    v_exp_f32 v18, v18
    v_exp_f32 v19, v19
    v_add_f32 v168, v168, v16
    v_mfma_f32_32x32x16_bf16 a[48:63], v[124:127], v[48:51], a[48:63]
    ds_read_b128 v[104:107], v158 offset:49152
    v_add_f32 v169, v169, v17
    v_cvt_pk_bf16_f32 v16, v16, v17
    v_exp_f32 v20, v20
    v_mfma_f32_32x32x16_bf16 a[112:127], v[124:127], v[64:67], a[112:127]
    s_waitcnt lgkmcnt(14)
    ds_read_b128 v[108:111], v159 offset:49152
    v_exp_f32 v21, v21
    v_add_f32 v168, v168, v18
    v_add_f32 v169, v169, v19
    v_cvt_pk_bf16_f32 v17, v18, v19
    s_waitcnt lgkmcnt(8)
    v_mfma_f32_32x32x16_bf16 a[0:15], v[128:131], v[52:55], a[0:15]
    v_exp_f32 v22, v22
    v_exp_f32 v23, v23
    v_add_f32 v168, v168, v20
    v_add_f32 v169, v169, v21
    v_mfma_f32_32x32x16_bf16 a[64:79], v[128:131], v[68:71], a[64:79]
    v_cvt_pk_bf16_f32 v18, v20, v21
    v_exp_f32 v24, v24
    v_exp_f32 v25, v25
    v_add_f32 v168, v168, v22
    v_mfma_f32_32x32x16_bf16 a[16:31], v[132:135], v[52:55], a[16:31]
    v_add_f32 v169, v169, v23
    v_cvt_pk_bf16_f32 v19, v22, v23
    v_exp_f32 v26, v26
    v_exp_f32 v27, v27
    v_mfma_f32_32x32x16_bf16 a[80:95], v[132:135], v[68:71], a[80:95]
    v_add_f32 v168, v168, v24
    v_add_f32 v169, v169, v25
    v_cvt_pk_bf16_f32 v20, v24, v25
    v_exp_f32 v28, v28
    v_mfma_f32_32x32x16_bf16 a[32:47], v[136:139], v[52:55], a[32:47]
    v_exp_f32 v29, v29
    v_add_f32 v168, v168, v26
    v_add_f32 v169, v169, v27
    v_cvt_pk_bf16_f32 v21, v26, v27
    v_mfma_f32_32x32x16_bf16 a[96:111], v[136:139], v[68:71], a[96:111]
    v_exp_f32 v30, v30
    v_exp_f32 v31, v31
    v_add_f32 v168, v168, v28
    v_add_f32 v169, v169, v29
    v_mfma_f32_32x32x16_bf16 a[48:63], v[140:143], v[52:55], a[48:63]
    v_cvt_pk_bf16_f32 v22, v28, v29
    v_add_f32 v168, v168, v30
    v_mfma_f32_32x32x16_bf16 a[112:127], v[140:143], v[68:71], a[112:127]
    s_waitcnt vmcnt(0)
    s_barrier
    s_waitcnt lgkmcnt(0)
    v_mfma_f32_32x32x16_bf16 v[48:63], v[80:83], a[128:131], v[192:207]
    ds_read_b64_tr_b16 v[112:113], v164 offset:40960
    v_add_f32 v169, v169, v31
    v_cvt_pk_bf16_f32 v23, v30, v31
    v_exp_f32 v32, v32
    v_mfma_f32_32x32x16_bf16 v[64:79], v[80:83], a[160:163], v[208:223]
    ds_read_b64_tr_b16 v[114:115], v164 offset:43008
    v_exp_f32 v33, v33
    v_exp_f32 v34, v34
    v_mfma_f32_32x32x16_bf16 v[48:63], v[84:87], a[132:135], v[48:63]
    ds_read_b64_tr_b16 v[116:117], v165 offset:40960
    v_exp_f32 v35, v35
    v_add_f32 v173, v173, v32
    v_add_f32 v174, v174, v33
    v_mfma_f32_32x32x16_bf16 v[64:79], v[84:87], a[164:167], v[64:79]
    ds_read_b64_tr_b16 v[118:119], v165 offset:43008
    v_cvt_pk_bf16_f32 v32, v32, v33
    v_exp_f32 v36, v36
    v_mfma_f32_32x32x16_bf16 v[48:63], v[88:91], a[136:139], v[48:63]
    ds_read_b64_tr_b16 v[120:121], v166 offset:40960
    v_exp_f32 v37, v37
    v_add_f32 v173, v173, v34
    v_add_f32 v174, v174, v35
    v_mfma_f32_32x32x16_bf16 v[64:79], v[88:91], a[168:171], v[64:79]
    ds_read_b64_tr_b16 v[122:123], v166 offset:43008
    v_cvt_pk_bf16_f32 v33, v34, v35
    v_exp_f32 v38, v38
    v_mfma_f32_32x32x16_bf16 v[48:63], v[92:95], a[140:143], v[48:63]
    ds_read_b64_tr_b16 v[124:125], v167 offset:40960
    v_exp_f32 v39, v39
    v_add_f32 v173, v173, v36
    v_add_f32 v174, v174, v37
    v_mfma_f32_32x32x16_bf16 v[64:79], v[92:95], a[172:175], v[64:79]
    ds_read_b64_tr_b16 v[126:127], v167 offset:43008
    v_cvt_pk_bf16_f32 v34, v36, v37
    v_exp_f32 v40, v40
    v_mfma_f32_32x32x16_bf16 v[48:63], v[96:99], a[144:147], v[48:63]
    ds_read_b64_tr_b16 v[128:129], v164 offset:45056
    v_exp_f32 v41, v41
    v_add_f32 v173, v173, v38
    v_add_f32 v174, v174, v39
    v_mfma_f32_32x32x16_bf16 v[64:79], v[96:99], a[176:179], v[64:79]
    ds_read_b64_tr_b16 v[130:131], v164 offset:47104
    v_cvt_pk_bf16_f32 v35, v38, v39
    v_exp_f32 v42, v42
    v_mfma_f32_32x32x16_bf16 v[48:63], v[100:103], a[148:151], v[48:63]
    ds_read_b64_tr_b16 v[132:133], v165 offset:45056
    v_exp_f32 v43, v43
    v_add_f32 v173, v173, v40
    v_add_f32 v174, v174, v41
    v_mfma_f32_32x32x16_bf16 v[64:79], v[100:103], a[180:183], v[64:79]
    ds_read_b64_tr_b16 v[134:135], v165 offset:47104
    v_cvt_pk_bf16_f32 v36, v40, v41
    v_exp_f32 v44, v44
    v_mfma_f32_32x32x16_bf16 v[48:63], v[104:107], a[152:155], v[48:63]
    ds_read_b64_tr_b16 v[136:137], v166 offset:45056
    v_exp_f32 v45, v45
    v_add_f32 v173, v173, v42
    v_add_f32 v174, v174, v43
    v_mfma_f32_32x32x16_bf16 v[64:79], v[104:107], a[184:187], v[64:79]
    ds_read_b64_tr_b16 v[138:139], v166 offset:47104
    v_cvt_pk_bf16_f32 v37, v42, v43
    v_exp_f32 v46, v46
    v_mfma_f32_32x32x16_bf16 v[48:63], v[108:111], a[156:159], v[48:63]
    ds_read_b64_tr_b16 v[140:141], v167 offset:45056
    v_exp_f32 v47, v47
    v_add_f32 v173, v173, v44
    v_add_f32 v174, v174, v45
    v_mfma_f32_32x32x16_bf16 v[64:79], v[108:111], a[188:191], v[64:79]
    s_waitcnt lgkmcnt(14)
    ds_read_b64_tr_b16 v[142:143], v167 offset:47104
    v_cvt_pk_bf16_f32 v38, v44, v45
    v_add_f32 v173, v173, v46
    v_add_f32 v174, v174, v47
    v_cvt_pk_bf16_f32 v39, v46, v47
    s_cmp_eq_u32 s39, 0
    s_cbranch_scc1 L_ap77
    s_call_b64 s[40:41], L_apply
L_ap77:
    s_waitcnt lgkmcnt(8)
    v_mfma_f32_32x32x16_bf16 a[0:15], v[112:115], v[16:19], a[0:15]
    v_max3_f32 v171, v48, v49, v50
    v_max3_f32 v172, v51, v52, v53
    v_max3_f32 v171, v171, v54, v55
    v_max3_f32 v172, v172, v56, v57
    v_max3_f32 v171, v171, v58, v59
    v_max3_f32 v172, v172, v60, v61
    v_max3_f32 v171, v171, v62, v63
    v_mfma_f32_32x32x16_bf16 a[64:79], v[112:115], v[32:35], a[64:79]
    v_max_f32 v171, v171, v172
    v_max3_f32 v176, v64, v65, v66
    v_max3_f32 v177, v67, v68, v69
    v_max3_f32 v176, v176, v70, v71
    v_max3_f32 v177, v177, v72, v73
    v_max3_f32 v176, v176, v74, v75
    v_mfma_f32_32x32x16_bf16 a[16:31], v[116:119], v[16:19], a[16:31]
    v_max3_f32 v177, v177, v76, v77
    v_max3_f32 v176, v176, v78, v79
    v_max_f32 v176, v176, v177
    v_cmp_lt_f32 vcc, s37, v171
    s_cbranch_vccz L_sk75
    s_call_b64 s[40:41], L_rare01
L_sk75:
    v_cmp_lt_f32 vcc, s37, v176
    s_cbranch_vccz L_sk76
    s_call_b64 s[40:41], L_rare11
L_sk76:
    v_mfma_f32_32x32x16_bf16 a[80:95], v[116:119], v[32:35], a[80:95]
    v_exp_f32 v48, v48
    v_exp_f32 v49, v49
    v_exp_f32 v50, v50
    v_mfma_f32_32x32x16_bf16 a[32:47], v[120:123], v[16:19], a[32:47]
    v_exp_f32 v51, v51
    v_add_f32 v168, v168, v48
    v_add_f32 v169, v169, v49
    v_cvt_pk_bf16_f32 v48, v48, v49
    v_mfma_f32_32x32x16_bf16 a[96:111], v[120:123], v[32:35], a[96:111]
    v_exp_f32 v52, v52
    v_exp_f32 v53, v53
    v_add_f32 v168, v168, v50
    v_add_f32 v169, v169, v51
    v_mfma_f32_32x32x16_bf16 a[48:63], v[124:127], v[16:19], a[48:63]
    v_cvt_pk_bf16_f32 v49, v50, v51
    v_exp_f32 v54, v54
    v_exp_f32 v55, v55
    v_add_f32 v168, v168, v52
    v_mfma_f32_32x32x16_bf16 a[112:127], v[124:127], v[32:35], a[112:127]
    v_add_f32 v169, v169, v53
    v_cvt_pk_bf16_f32 v50, v52, v53
    v_exp_f32 v56, v56
    v_exp_f32 v57, v57
    s_waitcnt lgkmcnt(8)
    s_waitcnt lgkmcnt(6)
    v_mfma_f32_32x32x16_bf16 a[0:15], v[128:131], v[20:23], a[0:15]
    v_add_f32 v168, v168, v54
    v_add_f32 v169, v169, v55
    v_cvt_pk_bf16_f32 v51, v54, v55
    v_exp_f32 v58, v58
    v_mfma_f32_32x32x16_bf16 a[64:79], v[128:131], v[36:39], a[64:79]
    v_exp_f32 v59, v59
    v_add_f32 v168, v168, v56
    v_add_f32 v169, v169, v57
    v_cvt_pk_bf16_f32 v52, v56, v57
    s_waitcnt lgkmcnt(4)
    v_mfma_f32_32x32x16_bf16 a[16:31], v[132:135], v[20:23], a[16:31]
    v_exp_f32 v60, v60
    v_exp_f32 v61, v61
    v_add_f32 v168, v168, v58
    v_add_f32 v169, v169, v59
    v_mfma_f32_32x32x16_bf16 a[80:95], v[132:135], v[36:39], a[80:95]
    v_cvt_pk_bf16_f32 v53, v58, v59
    v_exp_f32 v62, v62
    v_exp_f32 v63, v63
    v_add_f32 v168, v168, v60
    s_waitcnt lgkmcnt(2)
    v_mfma_f32_32x32x16_bf16 a[32:47], v[136:139], v[20:23], a[32:47]
    v_add_f32 v169, v169, v61
    v_cvt_pk_bf16_f32 v54, v60, v61
    v_add_f32 v168, v168, v62
    v_mfma_f32_32x32x16_bf16 a[96:111], v[136:139], v[36:39], a[96:111]
    s_waitcnt lgkmcnt(0)
    v_mfma_f32_32x32x16_bf16 a[48:63], v[140:143], v[20:23], a[48:63]
    v_mfma_f32_32x32x16_bf16 a[112:127], v[140:143], v[36:39], a[112:127]
    v_add_f32 v169, v169, v63
    v_cvt_pk_bf16_f32 v55, v62, v63
    v_exp_f32 v64, v64
    v_exp_f32 v65, v65
    v_exp_f32 v66, v66
    v_exp_f32 v67, v67
    v_add_f32 v173, v173, v64
    v_add_f32 v174, v174, v65
    v_cvt_pk_bf16_f32 v64, v64, v65
    v_exp_f32 v68, v68
    v_exp_f32 v69, v69
    v_add_f32 v173, v173, v66
    v_add_f32 v174, v174, v67
    v_cvt_pk_bf16_f32 v65, v66, v67
    v_exp_f32 v70, v70
    v_exp_f32 v71, v71
    v_add_f32 v173, v173, v68
    v_add_f32 v174, v174, v69
    v_cvt_pk_bf16_f32 v66, v68, v69
    v_exp_f32 v72, v72
    v_exp_f32 v73, v73
    v_add_f32 v173, v173, v70
    v_add_f32 v174, v174, v71
    v_cvt_pk_bf16_f32 v67, v70, v71
    v_exp_f32 v74, v74
    v_exp_f32 v75, v75
    v_add_f32 v173, v173, v72
    v_add_f32 v174, v174, v73
    v_cvt_pk_bf16_f32 v68, v72, v73
    v_exp_f32 v76, v76
    v_exp_f32 v77, v77
    v_add_f32 v173, v173, v74
    v_add_f32 v174, v174, v75
    v_cvt_pk_bf16_f32 v69, v74, v75
    v_exp_f32 v78, v78
    v_exp_f32 v79, v79
    v_add_f32 v173, v173, v76
    v_add_f32 v174, v174, v77
    v_cvt_pk_bf16_f32 v70, v76, v77
    v_add_f32 v173, v173, v78
    v_add_f32 v174, v174, v79
    v_cvt_pk_bf16_f32 v71, v78, v79
    ds_read_b64_tr_b16 v[112:113], v164 offset:57344
    ds_read_b64_tr_b16 v[114:115], v164 offset:59392
    ds_read_b64_tr_b16 v[116:117], v165 offset:57344
    ds_read_b64_tr_b16 v[118:119], v165 offset:59392
    ds_read_b64_tr_b16 v[120:121], v166 offset:57344
    ds_read_b64_tr_b16 v[122:123], v166 offset:59392
    ds_read_b64_tr_b16 v[124:125], v167 offset:57344
    ds_read_b64_tr_b16 v[126:127], v167 offset:59392
    ds_read_b64_tr_b16 v[128:129], v164 offset:61440
    ds_read_b64_tr_b16 v[130:131], v164 offset:63488
    ds_read_b64_tr_b16 v[132:133], v165 offset:61440
    ds_read_b64_tr_b16 v[134:135], v165 offset:63488
    ds_read_b64_tr_b16 v[136:137], v166 offset:61440
    ds_read_b64_tr_b16 v[138:139], v166 offset:63488
    ds_read_b64_tr_b16 v[140:141], v167 offset:61440
    s_waitcnt lgkmcnt(14)
    ds_read_b64_tr_b16 v[142:143], v167 offset:63488
    s_cmp_eq_u32 s39, 0
    s_cbranch_scc1 L_ap82
    s_call_b64 s[40:41], L_apply
L_ap82:
    s_waitcnt lgkmcnt(8)
    v_mfma_f32_32x32x16_bf16 a[0:15], v[112:115], v[48:51], a[0:15]
    v_mfma_f32_32x32x16_bf16 a[64:79], v[112:115], v[64:67], a[64:79]
    v_mfma_f32_32x32x16_bf16 a[16:31], v[116:119], v[48:51], a[16:31]
    v_mfma_f32_32x32x16_bf16 a[80:95], v[116:119], v[64:67], a[80:95]
    v_mfma_f32_32x32x16_bf16 a[32:47], v[120:123], v[48:51], a[32:47]
    v_mfma_f32_32x32x16_bf16 a[96:111], v[120:123], v[64:67], a[96:111]
    v_mfma_f32_32x32x16_bf16 a[48:63], v[124:127], v[48:51], a[48:63]
    v_mfma_f32_32x32x16_bf16 a[112:127], v[124:127], v[64:67], a[112:127]
    s_waitcnt lgkmcnt(8)
    s_waitcnt lgkmcnt(6)
    v_mfma_f32_32x32x16_bf16 a[0:15], v[128:131], v[52:55], a[0:15]
    v_mfma_f32_32x32x16_bf16 a[64:79], v[128:131], v[68:71], a[64:79]
    s_waitcnt lgkmcnt(4)
    v_mfma_f32_32x32x16_bf16 a[16:31], v[132:135], v[52:55], a[16:31]
    v_mfma_f32_32x32x16_bf16 a[80:95], v[132:135], v[68:71], a[80:95]
    s_waitcnt lgkmcnt(2)
    v_mfma_f32_32x32x16_bf16 a[32:47], v[136:139], v[52:55], a[32:47]
    v_mfma_f32_32x32x16_bf16 a[96:111], v[136:139], v[68:71], a[96:111]
    s_waitcnt lgkmcnt(0)
    v_mfma_f32_32x32x16_bf16 a[48:63], v[140:143], v[52:55], a[48:63]
    v_mfma_f32_32x32x16_bf16 a[112:127], v[140:143], v[68:71], a[112:127]
    s_waitcnt lgkmcnt(0)
    s_barrier
    s_lshl_b32 s46, s49, 2
    s_add_u32 s46, s46, s43
    s_lshl_b32 s47, s46, 2
    v_mov_b32 v2, s47
    buffer_load_dword v3, v2, s[32:35], 0 offen
    s_lshl_b32 s50, s46, 13
    s_add_u32 s50, s50, 4096
    v_lshrrev_b32 v244, 4, v1
    v_lshlrev_b32 v246, 8, v244
    v_sub_u32 v246, v186, v246
    v_lshlrev_b32 v244, 2, v244
    v_lshrrev_b32 v245, 5, v1
    v_lshlrev_b32 v245, 4, v245
    buffer_load_dword v247, v244, s[32:35], s50 offen offset:0
    buffer_load_dword v248, v244, s[32:35], s50 offen offset:16
    buffer_load_dword v249, v244, s[32:35], s50 offen offset:32
    buffer_load_dword v250, v244, s[32:35], s50 offen offset:48
    buffer_load_dword v251, v244, s[32:35], s50 offen offset:64
    buffer_load_dword v252, v244, s[32:35], s50 offen offset:80
    buffer_load_dword v253, v244, s[32:35], s50 offen offset:96
    buffer_load_dword v254, v244, s[32:35], s50 offen offset:112
    s_lshl_b32 s46, s43, 14
    v_add_u32 v144, s46, v144
    v_add_u32 v145, s46, v145
    v_add_u32 v146, s46, v146
    v_add_u32 v147, s46, v147
    v_add_u32 v148, s46, v148
    v_add_u32 v149, s46, v149
    v_add_u32 v150, s46, v150
    v_add_u32 v151, s46, v151
    v_add_u32 v160, s46, v160
    v_add_u32 v161, s46, v161
    v_add_u32 v162, s46, v162
    v_add_u32 v163, s46, v163
    v_add_u32 v152, s46, v152
    v_add_u32 v153, s46, v153
    v_add_u32 v154, s46, v154
    v_add_u32 v155, s46, v155
    v_add_u32 v156, s46, v156
    v_add_u32 v157, s46, v157
    v_add_u32 v158, s46, v158
    v_add_u32 v159, s46, v159
    v_add_u32 v164, s46, v164
    v_add_u32 v165, s46, v165
    v_add_u32 v166, s46, v166
    v_add_u32 v167, s46, v167
    s_waitcnt vmcnt(0)
    v_readfirstlane_b32 s45, v3
    s_nop 3
    s_min_u32 s45, s45, 2048
    s_add_u32 s45, s45, 31
    s_lshr_b32 s45, s45, 5
    s_cmp_eq_u32 s45, 0
    s_cbranch_scc1 L_epi
    v_and_b32 v247, 0xffff, v247
    v_lshl_add_u32 v112, v247, 8, v240
    v_lshl_add_u32 v120, v247, 8, v246
    v_and_b32 v248, 0xffff, v248
    v_lshl_add_u32 v113, v248, 8, v241
    v_lshl_add_u32 v121, v248, 8, v246
    v_and_b32 v249, 0xffff, v249
    v_lshl_add_u32 v114, v249, 8, v242
    v_lshl_add_u32 v122, v249, 8, v246
    v_and_b32 v250, 0xffff, v250
    v_lshl_add_u32 v115, v250, 8, v243
    v_lshl_add_u32 v123, v250, 8, v246
    v_and_b32 v251, 0xffff, v251
    v_lshl_add_u32 v116, v251, 8, v240
    v_lshl_add_u32 v124, v251, 8, v246
    v_and_b32 v252, 0xffff, v252
    v_lshl_add_u32 v117, v252, 8, v241
    v_lshl_add_u32 v125, v252, 8, v246
    v_and_b32 v253, 0xffff, v253
    v_lshl_add_u32 v118, v253, 8, v242
    v_lshl_add_u32 v126, v253, 8, v246
    v_and_b32 v254, 0xffff, v254
    v_lshl_add_u32 v119, v254, 8, v243
    v_lshl_add_u32 v127, v254, 8, v246
    s_add_u32 m0, s46, 0
    s_nop 0
    buffer_load_dwordx4 v112, s[20:23], 0 offen lds
    s_add_u32 m0, s46, 8192
    s_nop 0
    buffer_load_dwordx4 v120, s[24:27], 0 offen lds
    s_add_u32 m0, s46, 1024
    s_nop 0
    buffer_load_dwordx4 v113, s[20:23], 0 offen lds
    s_add_u32 m0, s46, 9216
    s_nop 0
    buffer_load_dwordx4 v121, s[24:27], 0 offen lds
    s_add_u32 m0, s46, 2048
    s_nop 0
    buffer_load_dwordx4 v114, s[20:23], 0 offen lds
    s_add_u32 m0, s46, 10240
    s_nop 0
    buffer_load_dwordx4 v122, s[24:27], 0 offen lds
    s_add_u32 m0, s46, 3072
    s_nop 0
    buffer_load_dwordx4 v115, s[20:23], 0 offen lds
    s_add_u32 m0, s46, 11264
    s_nop 0
    buffer_load_dwordx4 v123, s[24:27], 0 offen lds
    s_add_u32 m0, s46, 4096
    s_nop 0
    buffer_load_dwordx4 v116, s[20:23], 0 offen lds
    s_add_u32 m0, s46, 12288
    s_nop 0
    buffer_load_dwordx4 v124, s[24:27], 0 offen lds
    s_add_u32 m0, s46, 5120
    s_nop 0
    buffer_load_dwordx4 v117, s[20:23], 0 offen lds
    s_add_u32 m0, s46, 13312
    s_nop 0
    buffer_load_dwordx4 v125, s[24:27], 0 offen lds
    s_add_u32 m0, s46, 6144
    s_nop 0
    buffer_load_dwordx4 v118, s[20:23], 0 offen lds
    s_add_u32 m0, s46, 14336
    s_nop 0
    buffer_load_dwordx4 v126, s[24:27], 0 offen lds
    s_add_u32 m0, s46, 7168
    s_nop 0
    buffer_load_dwordx4 v119, s[20:23], 0 offen lds
    s_add_u32 m0, s46, 15360
    s_nop 0
    buffer_load_dwordx4 v127, s[24:27], 0 offen lds
    buffer_load_dwordx4 v[48:51], v245, s[32:35], s50 offen offset:0
    buffer_load_dwordx4 v[52:55], v245, s[32:35], s50 offen offset:32
    buffer_load_dwordx4 v[56:59], v245, s[32:35], s50 offen offset:64
    buffer_load_dwordx4 v[60:63], v245, s[32:35], s50 offen offset:96
    buffer_load_dword v247, v244, s[32:35], s50 offen offset:128
    buffer_load_dword v248, v244, s[32:35], s50 offen offset:144
    buffer_load_dword v249, v244, s[32:35], s50 offen offset:160
    buffer_load_dword v250, v244, s[32:35], s50 offen offset:176
    buffer_load_dword v251, v244, s[32:35], s50 offen offset:192
    buffer_load_dword v252, v244, s[32:35], s50 offen offset:208
    buffer_load_dword v253, v244, s[32:35], s50 offen offset:224
    buffer_load_dword v254, v244, s[32:35], s50 offen offset:240
L_tree:
    s_waitcnt vmcnt(0)
    s_cmp_le_u32 s45, 1
    s_cbranch_scc1 L_tn83
    v_and_b32 v247, 0xffff, v247
    v_lshl_add_u32 v112, v247, 8, v240
    v_lshl_add_u32 v120, v247, 8, v246
    v_and_b32 v248, 0xffff, v248
    v_lshl_add_u32 v113, v248, 8, v241
    v_lshl_add_u32 v121, v248, 8, v246
    v_and_b32 v249, 0xffff, v249
    v_lshl_add_u32 v114, v249, 8, v242
    v_lshl_add_u32 v122, v249, 8, v246
    v_and_b32 v250, 0xffff, v250
    v_lshl_add_u32 v115, v250, 8, v243
    v_lshl_add_u32 v123, v250, 8, v246
    v_and_b32 v251, 0xffff, v251
    v_lshl_add_u32 v116, v251, 8, v240
    v_lshl_add_u32 v124, v251, 8, v246
    v_and_b32 v252, 0xffff, v252
    v_lshl_add_u32 v117, v252, 8, v241
    v_lshl_add_u32 v125, v252, 8, v246
    v_and_b32 v253, 0xffff, v253
    v_lshl_add_u32 v118, v253, 8, v242
    v_lshl_add_u32 v126, v253, 8, v246
    v_and_b32 v254, 0xffff, v254
    v_lshl_add_u32 v119, v254, 8, v243
    v_lshl_add_u32 v127, v254, 8, v246
    s_add_u32 m0, s46, 65536
    s_nop 0
    buffer_load_dwordx4 v112, s[20:23], 0 offen lds
    s_add_u32 m0, s46, 73728
    s_nop 0
    buffer_load_dwordx4 v120, s[24:27], 0 offen lds
    s_add_u32 m0, s46, 66560
    s_nop 0
    buffer_load_dwordx4 v113, s[20:23], 0 offen lds
    s_add_u32 m0, s46, 74752
    s_nop 0
    buffer_load_dwordx4 v121, s[24:27], 0 offen lds
    s_add_u32 m0, s46, 67584
    s_nop 0
    buffer_load_dwordx4 v114, s[20:23], 0 offen lds
    s_add_u32 m0, s46, 75776
    s_nop 0
    buffer_load_dwordx4 v122, s[24:27], 0 offen lds
    s_add_u32 m0, s46, 68608
    s_nop 0
    buffer_load_dwordx4 v115, s[20:23], 0 offen lds
    s_add_u32 m0, s46, 76800
    s_nop 0
    buffer_load_dwordx4 v123, s[24:27], 0 offen lds
    s_add_u32 m0, s46, 69632
    s_nop 0
    buffer_load_dwordx4 v116, s[20:23], 0 offen lds
    s_add_u32 m0, s46, 77824
    s_nop 0
    buffer_load_dwordx4 v124, s[24:27], 0 offen lds
    s_add_u32 m0, s46, 70656
    s_nop 0
    buffer_load_dwordx4 v117, s[20:23], 0 offen lds
    s_add_u32 m0, s46, 78848
    s_nop 0
    buffer_load_dwordx4 v125, s[24:27], 0 offen lds
    s_add_u32 m0, s46, 71680
    s_nop 0
    buffer_load_dwordx4 v118, s[20:23], 0 offen lds
    s_add_u32 m0, s46, 79872
    s_nop 0
    buffer_load_dwordx4 v126, s[24:27], 0 offen lds
    s_add_u32 m0, s46, 72704
    s_nop 0
    buffer_load_dwordx4 v119, s[20:23], 0 offen lds
    s_add_u32 m0, s46, 80896
    s_nop 0
    buffer_load_dwordx4 v127, s[24:27], 0 offen lds
    buffer_load_dwordx4 v[64:67], v245, s[32:35], s50 offen offset:128
    buffer_load_dwordx4 v[68:71], v245, s[32:35], s50 offen offset:160
    buffer_load_dwordx4 v[72:75], v245, s[32:35], s50 offen offset:192
    buffer_load_dwordx4 v[76:79], v245, s[32:35], s50 offen offset:224
    buffer_load_dword v247, v244, s[32:35], s50 offen offset:256
    buffer_load_dword v248, v244, s[32:35], s50 offen offset:272
    buffer_load_dword v249, v244, s[32:35], s50 offen offset:288
    buffer_load_dword v250, v244, s[32:35], s50 offen offset:304
    buffer_load_dword v251, v244, s[32:35], s50 offen offset:320
    buffer_load_dword v252, v244, s[32:35], s50 offen offset:336
    buffer_load_dword v253, v244, s[32:35], s50 offen offset:352
    buffer_load_dword v254, v244, s[32:35], s50 offen offset:368
L_tn83:
    s_add_u32 s50, s50, 128
    ds_read_b128 v[80:83], v144
    ds_read_b128 v[84:87], v145
    ds_read_b128 v[88:91], v146
    ds_read_b128 v[92:95], v147
    ds_read_b128 v[96:99], v148
    ds_read_b128 v[100:103], v149
    ds_read_b128 v[104:107], v150
    ds_read_b128 v[108:111], v151
    s_waitcnt lgkmcnt(7)
    v_mfma_f32_32x32x16_bf16 v[16:31], v[80:83], a[128:131], v[192:207]
    v_mfma_f32_32x32x16_bf16 v[32:47], v[80:83], a[160:163], v[208:223]
    s_waitcnt lgkmcnt(6)
    v_mfma_f32_32x32x16_bf16 v[16:31], v[84:87], a[132:135], v[16:31]
    v_mfma_f32_32x32x16_bf16 v[32:47], v[84:87], a[164:167], v[32:47]
    s_waitcnt lgkmcnt(5)
    v_mfma_f32_32x32x16_bf16 v[16:31], v[88:91], a[136:139], v[16:31]
    v_mfma_f32_32x32x16_bf16 v[32:47], v[88:91], a[168:171], v[32:47]
    s_waitcnt lgkmcnt(4)
    v_mfma_f32_32x32x16_bf16 v[16:31], v[92:95], a[140:143], v[16:31]
    v_mfma_f32_32x32x16_bf16 v[32:47], v[92:95], a[172:175], v[32:47]
    s_waitcnt lgkmcnt(3)
    v_mfma_f32_32x32x16_bf16 v[16:31], v[96:99], a[144:147], v[16:31]
    v_mfma_f32_32x32x16_bf16 v[32:47], v[96:99], a[176:179], v[32:47]
    s_waitcnt lgkmcnt(2)
    v_mfma_f32_32x32x16_bf16 v[16:31], v[100:103], a[148:151], v[16:31]
    v_mfma_f32_32x32x16_bf16 v[32:47], v[100:103], a[180:183], v[32:47]
    s_waitcnt lgkmcnt(1)
    v_mfma_f32_32x32x16_bf16 v[16:31], v[104:107], a[152:155], v[16:31]
    v_mfma_f32_32x32x16_bf16 v[32:47], v[104:107], a[184:187], v[32:47]
    s_waitcnt lgkmcnt(0)
    v_mfma_f32_32x32x16_bf16 v[16:31], v[108:111], a[156:159], v[16:31]
    v_mfma_f32_32x32x16_bf16 v[32:47], v[108:111], a[188:191], v[32:47]
    ds_read_b64_tr_b16 v[112:113], v160 offset:8192
    ds_read_b64_tr_b16 v[114:115], v160 offset:10240
    ds_read_b64_tr_b16 v[116:117], v161 offset:8192
    ds_read_b64_tr_b16 v[118:119], v161 offset:10240
    ds_read_b64_tr_b16 v[120:121], v162 offset:8192
    ds_read_b64_tr_b16 v[122:123], v162 offset:10240
    ds_read_b64_tr_b16 v[124:125], v163 offset:8192
    ds_read_b64_tr_b16 v[126:127], v163 offset:10240
    ds_read_b64_tr_b16 v[128:129], v160 offset:12288
    ds_read_b64_tr_b16 v[130:131], v160 offset:14336
    ds_read_b64_tr_b16 v[132:133], v161 offset:12288
    ds_read_b64_tr_b16 v[134:135], v161 offset:14336
    ds_read_b64_tr_b16 v[136:137], v162 offset:12288
    ds_read_b64_tr_b16 v[138:139], v162 offset:14336
    ds_read_b64_tr_b16 v[140:141], v163 offset:12288
    s_waitcnt lgkmcnt(14)
    ds_read_b64_tr_b16 v[142:143], v163 offset:14336
    v_bfe_i32 v2, v48, v236, 1
    v_bfi_b32 v16, v2, v16, v238
    v_bfe_i32 v3, v49, v236, 1
    v_bfi_b32 v17, v3, v17, v238
    v_bfe_i32 v2, v50, v236, 1
    v_bfi_b32 v18, v2, v18, v238
    v_bfe_i32 v3, v51, v236, 1
    v_bfi_b32 v19, v3, v19, v238
    v_bfe_i32 v2, v52, v236, 1
    v_bfi_b32 v20, v2, v20, v238
    v_bfe_i32 v3, v53, v236, 1
    v_bfi_b32 v21, v3, v21, v238
    v_bfe_i32 v2, v54, v236, 1
    v_bfi_b32 v22, v2, v22, v238
    v_bfe_i32 v3, v55, v236, 1
    v_bfi_b32 v23, v3, v23, v238
    v_bfe_i32 v2, v56, v236, 1
    v_bfi_b32 v24, v2, v24, v238
    v_bfe_i32 v3, v57, v236, 1
    v_bfi_b32 v25, v3, v25, v238
    v_bfe_i32 v2, v58, v236, 1
    v_bfi_b32 v26, v2, v26, v238
    v_bfe_i32 v3, v59, v236, 1
    v_bfi_b32 v27, v3, v27, v238
    v_bfe_i32 v2, v60, v236, 1
    v_bfi_b32 v28, v2, v28, v238
    v_bfe_i32 v3, v61, v236, 1
    v_bfi_b32 v29, v3, v29, v238
    v_bfe_i32 v2, v62, v236, 1
    v_bfi_b32 v30, v2, v30, v238
    v_bfe_i32 v3, v63, v236, 1
    v_bfi_b32 v31, v3, v31, v238
    v_max3_f32 v171, v16, v17, v18
    v_max3_f32 v172, v19, v20, v21
    v_max3_f32 v171, v171, v22, v23
    v_max3_f32 v172, v172, v24, v25
    v_max3_f32 v171, v171, v26, v27
    v_max3_f32 v172, v172, v28, v29
    v_max3_f32 v171, v171, v30, v31
    v_max_f32 v171, v171, v172
    v_cmp_lt_f32 vcc, s37, v171
    s_cbranch_vccz L_sk84
    s_call_b64 s[40:41], L_rare00
L_sk84:
    v_exp_f32 v16, v16
    v_exp_f32 v17, v17
    v_exp_f32 v18, v18
    v_exp_f32 v19, v19
    v_add_f32 v168, v168, v16
    v_add_f32 v169, v169, v17
    v_cvt_pk_bf16_f32 v16, v16, v17
    v_exp_f32 v20, v20
    v_exp_f32 v21, v21
    v_add_f32 v168, v168, v18
    v_add_f32 v169, v169, v19
    v_cvt_pk_bf16_f32 v17, v18, v19
    v_exp_f32 v22, v22
    v_exp_f32 v23, v23
    v_add_f32 v168, v168, v20
    v_add_f32 v169, v169, v21
    v_cvt_pk_bf16_f32 v18, v20, v21
    v_exp_f32 v24, v24
    v_exp_f32 v25, v25
    v_add_f32 v168, v168, v22
    v_add_f32 v169, v169, v23
    v_cvt_pk_bf16_f32 v19, v22, v23
    v_exp_f32 v26, v26
    v_exp_f32 v27, v27
    v_add_f32 v168, v168, v24
    v_add_f32 v169, v169, v25
    v_cvt_pk_bf16_f32 v20, v24, v25
    v_exp_f32 v28, v28
    v_exp_f32 v29, v29
    v_add_f32 v168, v168, v26
    v_add_f32 v169, v169, v27
    v_cvt_pk_bf16_f32 v21, v26, v27
    v_exp_f32 v30, v30
    v_exp_f32 v31, v31
    v_add_f32 v168, v168, v28
    v_add_f32 v169, v169, v29
    v_cvt_pk_bf16_f32 v22, v28, v29
    v_add_f32 v168, v168, v30
    v_add_f32 v169, v169, v31
    v_cvt_pk_bf16_f32 v23, v30, v31
    v_bfe_i32 v2, v48, v237, 1
    v_bfi_b32 v32, v2, v32, v238
    v_bfe_i32 v3, v49, v237, 1
    v_bfi_b32 v33, v3, v33, v238
    v_bfe_i32 v2, v50, v237, 1
    v_bfi_b32 v34, v2, v34, v238
    v_bfe_i32 v3, v51, v237, 1
    v_bfi_b32 v35, v3, v35, v238
    v_bfe_i32 v2, v52, v237, 1
    v_bfi_b32 v36, v2, v36, v238
    v_bfe_i32 v3, v53, v237, 1
    v_bfi_b32 v37, v3, v37, v238
    v_bfe_i32 v2, v54, v237, 1
    v_bfi_b32 v38, v2, v38, v238
    v_bfe_i32 v3, v55, v237, 1
    v_bfi_b32 v39, v3, v39, v238
    v_bfe_i32 v2, v56, v237, 1
    v_bfi_b32 v40, v2, v40, v238
    v_bfe_i32 v3, v57, v237, 1
    v_bfi_b32 v41, v3, v41, v238
    v_bfe_i32 v2, v58, v237, 1
    v_bfi_b32 v42, v2, v42, v238
    v_bfe_i32 v3, v59, v237, 1
    v_bfi_b32 v43, v3, v43, v238
    v_bfe_i32 v2, v60, v237, 1
    v_bfi_b32 v44, v2, v44, v238
    v_bfe_i32 v3, v61, v237, 1
    v_bfi_b32 v45, v3, v45, v238
    v_bfe_i32 v2, v62, v237, 1
    v_bfi_b32 v46, v2, v46, v238
    v_bfe_i32 v3, v63, v237, 1
    v_bfi_b32 v47, v3, v47, v238
    v_max3_f32 v176, v32, v33, v34
    v_max3_f32 v177, v35, v36, v37
    v_max3_f32 v176, v176, v38, v39
    v_max3_f32 v177, v177, v40, v41
    v_max3_f32 v176, v176, v42, v43
    v_max3_f32 v177, v177, v44, v45
    v_max3_f32 v176, v176, v46, v47
    v_max_f32 v176, v176, v177
    v_cmp_lt_f32 vcc, s37, v176
    s_cbranch_vccz L_sk85
    s_call_b64 s[40:41], L_rare10
L_sk85:
    v_exp_f32 v32, v32
    v_exp_f32 v33, v33
    v_exp_f32 v34, v34
    v_exp_f32 v35, v35
    v_add_f32 v173, v173, v32
    v_add_f32 v174, v174, v33
    v_cvt_pk_bf16_f32 v32, v32, v33
    v_exp_f32 v36, v36
    v_exp_f32 v37, v37
    v_add_f32 v173, v173, v34
    v_add_f32 v174, v174, v35
    v_cvt_pk_bf16_f32 v33, v34, v35
    v_exp_f32 v38, v38
    v_exp_f32 v39, v39
    v_add_f32 v173, v173, v36
    v_add_f32 v174, v174, v37
    v_cvt_pk_bf16_f32 v34, v36, v37
    v_exp_f32 v40, v40
    v_exp_f32 v41, v41
    v_add_f32 v173, v173, v38
    v_add_f32 v174, v174, v39
    v_cvt_pk_bf16_f32 v35, v38, v39
    v_exp_f32 v42, v42
    v_exp_f32 v43, v43
    v_add_f32 v173, v173, v40
    v_add_f32 v174, v174, v41
    v_cvt_pk_bf16_f32 v36, v40, v41
    v_exp_f32 v44, v44
    v_exp_f32 v45, v45
    v_add_f32 v173, v173, v42
    v_add_f32 v174, v174, v43
    v_cvt_pk_bf16_f32 v37, v42, v43
    v_exp_f32 v46, v46
    v_exp_f32 v47, v47
    v_add_f32 v173, v173, v44
    v_add_f32 v174, v174, v45
    v_cvt_pk_bf16_f32 v38, v44, v45
    v_add_f32 v173, v173, v46
    v_add_f32 v174, v174, v47
    v_cvt_pk_bf16_f32 v39, v46, v47
    s_cmp_eq_u32 s39, 0
    s_cbranch_scc1 L_ap86
    s_call_b64 s[40:41], L_apply
L_ap86:
    s_waitcnt lgkmcnt(14)
    v_mfma_f32_32x32x16_bf16 a[0:15], v[112:115], v[16:19], a[0:15]
    v_mfma_f32_32x32x16_bf16 a[64:79], v[112:115], v[32:35], a[64:79]
    s_waitcnt lgkmcnt(12)
    v_mfma_f32_32x32x16_bf16 a[16:31], v[116:119], v[16:19], a[16:31]
    v_mfma_f32_32x32x16_bf16 a[80:95], v[116:119], v[32:35], a[80:95]
    s_waitcnt lgkmcnt(10)
    v_mfma_f32_32x32x16_bf16 a[32:47], v[120:123], v[16:19], a[32:47]
    v_mfma_f32_32x32x16_bf16 a[96:111], v[120:123], v[32:35], a[96:111]
    s_waitcnt lgkmcnt(8)
    v_mfma_f32_32x32x16_bf16 a[48:63], v[124:127], v[16:19], a[48:63]
    v_mfma_f32_32x32x16_bf16 a[112:127], v[124:127], v[32:35], a[112:127]
    s_waitcnt lgkmcnt(6)
    v_mfma_f32_32x32x16_bf16 a[0:15], v[128:131], v[20:23], a[0:15]
    v_mfma_f32_32x32x16_bf16 a[64:79], v[128:131], v[36:39], a[64:79]
    s_waitcnt lgkmcnt(4)
    v_mfma_f32_32x32x16_bf16 a[16:31], v[132:135], v[20:23], a[16:31]
    v_mfma_f32_32x32x16_bf16 a[80:95], v[132:135], v[36:39], a[80:95]
    s_waitcnt lgkmcnt(2)
    v_mfma_f32_32x32x16_bf16 a[32:47], v[136:139], v[20:23], a[32:47]
    v_mfma_f32_32x32x16_bf16 a[96:111], v[136:139], v[36:39], a[96:111]
    s_waitcnt lgkmcnt(0)
    v_mfma_f32_32x32x16_bf16 a[48:63], v[140:143], v[20:23], a[48:63]
    v_mfma_f32_32x32x16_bf16 a[112:127], v[140:143], v[36:39], a[112:127]
    s_sub_u32 s45, s45, 1
    s_cmp_eq_u32 s45, 0
    s_cbranch_scc1 L_tdone
    s_waitcnt vmcnt(0)
    s_cmp_le_u32 s45, 1
    s_cbranch_scc1 L_tn87
    v_and_b32 v247, 0xffff, v247
    v_lshl_add_u32 v112, v247, 8, v240
    v_lshl_add_u32 v120, v247, 8, v246
    v_and_b32 v248, 0xffff, v248
    v_lshl_add_u32 v113, v248, 8, v241
    v_lshl_add_u32 v121, v248, 8, v246
    v_and_b32 v249, 0xffff, v249
    v_lshl_add_u32 v114, v249, 8, v242
    v_lshl_add_u32 v122, v249, 8, v246
    v_and_b32 v250, 0xffff, v250
    v_lshl_add_u32 v115, v250, 8, v243
    v_lshl_add_u32 v123, v250, 8, v246
    v_and_b32 v251, 0xffff, v251
    v_lshl_add_u32 v116, v251, 8, v240
    v_lshl_add_u32 v124, v251, 8, v246
    v_and_b32 v252, 0xffff, v252
    v_lshl_add_u32 v117, v252, 8, v241
    v_lshl_add_u32 v125, v252, 8, v246
    v_and_b32 v253, 0xffff, v253
    v_lshl_add_u32 v118, v253, 8, v242
    v_lshl_add_u32 v126, v253, 8, v246
    v_and_b32 v254, 0xffff, v254
    v_lshl_add_u32 v119, v254, 8, v243
    v_lshl_add_u32 v127, v254, 8, v246
    s_add_u32 m0, s46, 0
    s_nop 0
    buffer_load_dwordx4 v112, s[20:23], 0 offen lds
    s_add_u32 m0, s46, 8192
    s_nop 0
    buffer_load_dwordx4 v120, s[24:27], 0 offen lds
    s_add_u32 m0, s46, 1024
    s_nop 0
    buffer_load_dwordx4 v113, s[20:23], 0 offen lds
    s_add_u32 m0, s46, 9216
    s_nop 0
    buffer_load_dwordx4 v121, s[24:27], 0 offen lds
    s_add_u32 m0, s46, 2048
    s_nop 0
    buffer_load_dwordx4 v114, s[20:23], 0 offen lds
    s_add_u32 m0, s46, 10240
    s_nop 0
    buffer_load_dwordx4 v122, s[24:27], 0 offen lds
    s_add_u32 m0, s46, 3072
    s_nop 0
    buffer_load_dwordx4 v115, s[20:23], 0 offen lds
    s_add_u32 m0, s46, 11264
    s_nop 0
    buffer_load_dwordx4 v123, s[24:27], 0 offen lds
    s_add_u32 m0, s46, 4096
    s_nop 0
    buffer_load_dwordx4 v116, s[20:23], 0 offen lds
    s_add_u32 m0, s46, 12288
    s_nop 0
    buffer_load_dwordx4 v124, s[24:27], 0 offen lds
    s_add_u32 m0, s46, 5120
    s_nop 0
    buffer_load_dwordx4 v117, s[20:23], 0 offen lds
    s_add_u32 m0, s46, 13312
    s_nop 0
    buffer_load_dwordx4 v125, s[24:27], 0 offen lds
    s_add_u32 m0, s46, 6144
    s_nop 0
    buffer_load_dwordx4 v118, s[20:23], 0 offen lds
    s_add_u32 m0, s46, 14336
    s_nop 0
    buffer_load_dwordx4 v126, s[24:27], 0 offen lds
    s_add_u32 m0, s46, 7168
    s_nop 0
    buffer_load_dwordx4 v119, s[20:23], 0 offen lds
    s_add_u32 m0, s46, 15360
    s_nop 0
    buffer_load_dwordx4 v127, s[24:27], 0 offen lds
    buffer_load_dwordx4 v[48:51], v245, s[32:35], s50 offen offset:128
    buffer_load_dwordx4 v[52:55], v245, s[32:35], s50 offen offset:160
    buffer_load_dwordx4 v[56:59], v245, s[32:35], s50 offen offset:192
    buffer_load_dwordx4 v[60:63], v245, s[32:35], s50 offen offset:224
    buffer_load_dword v247, v244, s[32:35], s50 offen offset:256
    buffer_load_dword v248, v244, s[32:35], s50 offen offset:272
    buffer_load_dword v249, v244, s[32:35], s50 offen offset:288
    buffer_load_dword v250, v244, s[32:35], s50 offen offset:304
    buffer_load_dword v251, v244, s[32:35], s50 offen offset:320
    buffer_load_dword v252, v244, s[32:35], s50 offen offset:336
    buffer_load_dword v253, v244, s[32:35], s50 offen offset:352
    buffer_load_dword v254, v244, s[32:35], s50 offen offset:368
L_tn87:
    s_add_u32 s50, s50, 128
    ds_read_b128 v[80:83], v152
    ds_read_b128 v[84:87], v153
    ds_read_b128 v[88:91], v154
    ds_read_b128 v[92:95], v155
    ds_read_b128 v[96:99], v156
    ds_read_b128 v[100:103], v157
    ds_read_b128 v[104:107], v158
    ds_read_b128 v[108:111], v159
    s_waitcnt lgkmcnt(7)
    v_mfma_f32_32x32x16_bf16 v[16:31], v[80:83], a[128:131], v[192:207]
    v_mfma_f32_32x32x16_bf16 v[32:47], v[80:83], a[160:163], v[208:223]
    s_waitcnt lgkmcnt(6)
    v_mfma_f32_32x32x16_bf16 v[16:31], v[84:87], a[132:135], v[16:31]
    v_mfma_f32_32x32x16_bf16 v[32:47], v[84:87], a[164:167], v[32:47]
    s_waitcnt lgkmcnt(5)
    v_mfma_f32_32x32x16_bf16 v[16:31], v[88:91], a[136:139], v[16:31]
    v_mfma_f32_32x32x16_bf16 v[32:47], v[88:91], a[168:171], v[32:47]
    s_waitcnt lgkmcnt(4)
    v_mfma_f32_32x32x16_bf16 v[16:31], v[92:95], a[140:143], v[16:31]
    v_mfma_f32_32x32x16_bf16 v[32:47], v[92:95], a[172:175], v[32:47]
    s_waitcnt lgkmcnt(3)
    v_mfma_f32_32x32x16_bf16 v[16:31], v[96:99], a[144:147], v[16:31]
    v_mfma_f32_32x32x16_bf16 v[32:47], v[96:99], a[176:179], v[32:47]
    s_waitcnt lgkmcnt(2)
    v_mfma_f32_32x32x16_bf16 v[16:31], v[100:103], a[148:151], v[16:31]
    v_mfma_f32_32x32x16_bf16 v[32:47], v[100:103], a[180:183], v[32:47]
    s_waitcnt lgkmcnt(1)
    v_mfma_f32_32x32x16_bf16 v[16:31], v[104:107], a[152:155], v[16:31]
    v_mfma_f32_32x32x16_bf16 v[32:47], v[104:107], a[184:187], v[32:47]
    s_waitcnt lgkmcnt(0)
    v_mfma_f32_32x32x16_bf16 v[16:31], v[108:111], a[156:159], v[16:31]
    v_mfma_f32_32x32x16_bf16 v[32:47], v[108:111], a[188:191], v[32:47]
    ds_read_b64_tr_b16 v[112:113], v164 offset:8192
    ds_read_b64_tr_b16 v[114:115], v164 offset:10240
    ds_read_b64_tr_b16 v[116:117], v165 offset:8192
    ds_read_b64_tr_b16 v[118:119], v165 offset:10240
    ds_read_b64_tr_b16 v[120:121], v166 offset:8192
    ds_read_b64_tr_b16 v[122:123], v166 offset:10240
    ds_read_b64_tr_b16 v[124:125], v167 offset:8192
    ds_read_b64_tr_b16 v[126:127], v167 offset:10240
    ds_read_b64_tr_b16 v[128:129], v164 offset:12288
    ds_read_b64_tr_b16 v[130:131], v164 offset:14336
    ds_read_b64_tr_b16 v[132:133], v165 offset:12288
    ds_read_b64_tr_b16 v[134:135], v165 offset:14336
    ds_read_b64_tr_b16 v[136:137], v166 offset:12288
    ds_read_b64_tr_b16 v[138:139], v166 offset:14336
    ds_read_b64_tr_b16 v[140:141], v167 offset:12288
    s_waitcnt lgkmcnt(14)
    ds_read_b64_tr_b16 v[142:143], v167 offset:14336
    v_bfe_i32 v2, v64, v236, 1
    v_bfi_b32 v16, v2, v16, v238
    v_bfe_i32 v3, v65, v236, 1
    v_bfi_b32 v17, v3, v17, v238
    v_bfe_i32 v2, v66, v236, 1
    v_bfi_b32 v18, v2, v18, v238
    v_bfe_i32 v3, v67, v236, 1
    v_bfi_b32 v19, v3, v19, v238
    v_bfe_i32 v2, v68, v236, 1
    v_bfi_b32 v20, v2, v20, v238
    v_bfe_i32 v3, v69, v236, 1
    v_bfi_b32 v21, v3, v21, v238
    v_bfe_i32 v2, v70, v236, 1
    v_bfi_b32 v22, v2, v22, v238
    v_bfe_i32 v3, v71, v236, 1
    v_bfi_b32 v23, v3, v23, v238
    v_bfe_i32 v2, v72, v236, 1
    v_bfi_b32 v24, v2, v24, v238
    v_bfe_i32 v3, v73, v236, 1
    v_bfi_b32 v25, v3, v25, v238
    v_bfe_i32 v2, v74, v236, 1
    v_bfi_b32 v26, v2, v26, v238
    v_bfe_i32 v3, v75, v236, 1
    v_bfi_b32 v27, v3, v27, v238
    v_bfe_i32 v2, v76, v236, 1
    v_bfi_b32 v28, v2, v28, v238
    v_bfe_i32 v3, v77, v236, 1
    v_bfi_b32 v29, v3, v29, v238
    v_bfe_i32 v2, v78, v236, 1
    v_bfi_b32 v30, v2, v30, v238
    v_bfe_i32 v3, v79, v236, 1
    v_bfi_b32 v31, v3, v31, v238
    v_max3_f32 v171, v16, v17, v18
    v_max3_f32 v172, v19, v20, v21
    v_max3_f32 v171, v171, v22, v23
    v_max3_f32 v172, v172, v24, v25
    v_max3_f32 v171, v171, v26, v27
    v_max3_f32 v172, v172, v28, v29
    v_max3_f32 v171, v171, v30, v31
    v_max_f32 v171, v171, v172
    v_cmp_lt_f32 vcc, s37, v171
    s_cbranch_vccz L_sk88
    s_call_b64 s[40:41], L_rare00
L_sk88:
    v_exp_f32 v16, v16
    v_exp_f32 v17, v17
    v_exp_f32 v18, v18
    v_exp_f32 v19, v19
    v_add_f32 v168, v168, v16
    v_add_f32 v169, v169, v17
    v_cvt_pk_bf16_f32 v16, v16, v17
    v_exp_f32 v20, v20
    v_exp_f32 v21, v21
    v_add_f32 v168, v168, v18
    v_add_f32 v169, v169, v19
    v_cvt_pk_bf16_f32 v17, v18, v19
    v_exp_f32 v22, v22
    v_exp_f32 v23, v23
    v_add_f32 v168, v168, v20
    v_add_f32 v169, v169, v21
    v_cvt_pk_bf16_f32 v18, v20, v21
    v_exp_f32 v24, v24
    v_exp_f32 v25, v25
    v_add_f32 v168, v168, v22
    v_add_f32 v169, v169, v23
    v_cvt_pk_bf16_f32 v19, v22, v23
    v_exp_f32 v26, v26
    v_exp_f32 v27, v27
    v_add_f32 v168, v168, v24
    v_add_f32 v169, v169, v25
    v_cvt_pk_bf16_f32 v20, v24, v25
    v_exp_f32 v28, v28
    v_exp_f32 v29, v29
    v_add_f32 v168, v168, v26
    v_add_f32 v169, v169, v27
    v_cvt_pk_bf16_f32 v21, v26, v27
    v_exp_f32 v30, v30
    v_exp_f32 v31, v31
    v_add_f32 v168, v168, v28
    v_add_f32 v169, v169, v29
    v_cvt_pk_bf16_f32 v22, v28, v29
    v_add_f32 v168, v168, v30
    v_add_f32 v169, v169, v31
    v_cvt_pk_bf16_f32 v23, v30, v31
    v_bfe_i32 v2, v64, v237, 1
    v_bfi_b32 v32, v2, v32, v238
    v_bfe_i32 v3, v65, v237, 1
    v_bfi_b32 v33, v3, v33, v238
    v_bfe_i32 v2, v66, v237, 1
    v_bfi_b32 v34, v2, v34, v238
    v_bfe_i32 v3, v67, v237, 1
    v_bfi_b32 v35, v3, v35, v238
    v_bfe_i32 v2, v68, v237, 1
    v_bfi_b32 v36, v2, v36, v238
    v_bfe_i32 v3, v69, v237, 1
    v_bfi_b32 v37, v3, v37, v238
    v_bfe_i32 v2, v70, v237, 1
    v_bfi_b32 v38, v2, v38, v238
    v_bfe_i32 v3, v71, v237, 1
    v_bfi_b32 v39, v3, v39, v238
    v_bfe_i32 v2, v72, v237, 1
    v_bfi_b32 v40, v2, v40, v238
    v_bfe_i32 v3, v73, v237, 1
    v_bfi_b32 v41, v3, v41, v238
    v_bfe_i32 v2, v74, v237, 1
    v_bfi_b32 v42, v2, v42, v238
    v_bfe_i32 v3, v75, v237, 1
    v_bfi_b32 v43, v3, v43, v238
    v_bfe_i32 v2, v76, v237, 1
    v_bfi_b32 v44, v2, v44, v238
    v_bfe_i32 v3, v77, v237, 1
    v_bfi_b32 v45, v3, v45, v238
    v_bfe_i32 v2, v78, v237, 1
    v_bfi_b32 v46, v2, v46, v238
    v_bfe_i32 v3, v79, v237, 1
    v_bfi_b32 v47, v3, v47, v238
    v_max3_f32 v176, v32, v33, v34
    v_max3_f32 v177, v35, v36, v37
    v_max3_f32 v176, v176, v38, v39
    v_max3_f32 v177, v177, v40, v41
    v_max3_f32 v176, v176, v42, v43
    v_max3_f32 v177, v177, v44, v45
    v_max3_f32 v176, v176, v46, v47
    v_max_f32 v176, v176, v177
    v_cmp_lt_f32 vcc, s37, v176
    s_cbranch_vccz L_sk89
    s_call_b64 s[40:41], L_rare10
L_sk89:
    v_exp_f32 v32, v32
    v_exp_f32 v33, v33
    v_exp_f32 v34, v34
    v_exp_f32 v35, v35
    v_add_f32 v173, v173, v32
    v_add_f32 v174, v174, v33
    v_cvt_pk_bf16_f32 v32, v32, v33
    v_exp_f32 v36, v36
    v_exp_f32 v37, v37
    v_add_f32 v173, v173, v34
    v_add_f32 v174, v174, v35
    v_cvt_pk_bf16_f32 v33, v34, v35
    v_exp_f32 v38, v38
    v_exp_f32 v39, v39
    v_add_f32 v173, v173, v36
    v_add_f32 v174, v174, v37
    v_cvt_pk_bf16_f32 v34, v36, v37
    v_exp_f32 v40, v40
    v_exp_f32 v41, v41
    v_add_f32 v173, v173, v38
    v_add_f32 v174, v174, v39
    v_cvt_pk_bf16_f32 v35, v38, v39
    v_exp_f32 v42, v42
    v_exp_f32 v43, v43
    v_add_f32 v173, v173, v40
    v_add_f32 v174, v174, v41
    v_cvt_pk_bf16_f32 v36, v40, v41
    v_exp_f32 v44, v44
    v_exp_f32 v45, v45
    v_add_f32 v173, v173, v42
    v_add_f32 v174, v174, v43
    v_cvt_pk_bf16_f32 v37, v42, v43
    v_exp_f32 v46, v46
    v_exp_f32 v47, v47
    v_add_f32 v173, v173, v44
    v_add_f32 v174, v174, v45
    v_cvt_pk_bf16_f32 v38, v44, v45
    v_add_f32 v173, v173, v46
    v_add_f32 v174, v174, v47
    v_cvt_pk_bf16_f32 v39, v46, v47
    s_cmp_eq_u32 s39, 0
    s_cbranch_scc1 L_ap90
    s_call_b64 s[40:41], L_apply
L_ap90:
    s_waitcnt lgkmcnt(14)
    v_mfma_f32_32x32x16_bf16 a[0:15], v[112:115], v[16:19], a[0:15]
    v_mfma_f32_32x32x16_bf16 a[64:79], v[112:115], v[32:35], a[64:79]
    s_waitcnt lgkmcnt(12)
    v_mfma_f32_32x32x16_bf16 a[16:31], v[116:119], v[16:19], a[16:31]
    v_mfma_f32_32x32x16_bf16 a[80:95], v[116:119], v[32:35], a[80:95]
    s_waitcnt lgkmcnt(10)
    v_mfma_f32_32x32x16_bf16 a[32:47], v[120:123], v[16:19], a[32:47]
    v_mfma_f32_32x32x16_bf16 a[96:111], v[120:123], v[32:35], a[96:111]
    s_waitcnt lgkmcnt(8)
    v_mfma_f32_32x32x16_bf16 a[48:63], v[124:127], v[16:19], a[48:63]
    v_mfma_f32_32x32x16_bf16 a[112:127], v[124:127], v[32:35], a[112:127]
    s_waitcnt lgkmcnt(6)
    v_mfma_f32_32x32x16_bf16 a[0:15], v[128:131], v[20:23], a[0:15]
    v_mfma_f32_32x32x16_bf16 a[64:79], v[128:131], v[36:39], a[64:79]
    s_waitcnt lgkmcnt(4)
    v_mfma_f32_32x32x16_bf16 a[16:31], v[132:135], v[20:23], a[16:31]
    v_mfma_f32_32x32x16_bf16 a[80:95], v[132:135], v[36:39], a[80:95]
    s_waitcnt lgkmcnt(2)
    v_mfma_f32_32x32x16_bf16 a[32:47], v[136:139], v[20:23], a[32:47]
    v_mfma_f32_32x32x16_bf16 a[96:111], v[136:139], v[36:39], a[96:111]
    s_waitcnt lgkmcnt(0)
    v_mfma_f32_32x32x16_bf16 a[48:63], v[140:143], v[20:23], a[48:63]
    v_mfma_f32_32x32x16_bf16 a[112:127], v[140:143], v[36:39], a[112:127]
    s_sub_u32 s45, s45, 1
    s_cmp_eq_u32 s45, 0
    s_cbranch_scc1 L_tdone
    s_branch L_tree
L_tdone:
    s_waitcnt vmcnt(0)
L_epi0:
L_epi:
    s_nop 15
    s_nop 15
    v_add_f32 v2, v168, v169
    v_mov_b32 v3, v2
    s_nop 1
    v_permlane32_swap_b32 v2, v3
    v_add_f32 v2, v2, v3
    v_rcp_f32 v8, v2
    v_add_f32 v2, v173, v174
    v_mov_b32 v3, v2
    s_nop 1
    v_permlane32_swap_b32 v2, v3
    v_add_f32 v2, v2, v3
    v_rcp_f32 v9, v2
    s_lshl_b32 s46, s43, 14
    v_and_b32 v4, 31, v1
    v_lshrrev_b32 v5, 5, v1
    v_lshlrev_b32 v5, 3, v5
    v_lshl_add_u32 v6, v4, 8, v5
    v_add_u32 v6, s46, v6
    v_and_b32 v7, 15, v4
    v_lshlrev_b32 v7, 4, v7
    v_accvgpr_read_b32 v10, a0
    v_accvgpr_read_b32 v11, a1
    v_accvgpr_read_b32 v12, a2
    v_accvgpr_read_b32 v13, a3
    v_mul_f32 v10, v10, v8
    v_mul_f32 v11, v11, v8
    v_mul_f32 v12, v12, v8
    v_mul_f32 v13, v13, v8
    v_cvt_pk_bf16_f32 v14, v10, v11
    v_cvt_pk_bf16_f32 v15, v12, v13
    v_xor_b32 v80, 0, v7
    v_add_u32 v80, v80, v6
    ds_write_b64 v80, v[14:15] offset:0
    v_accvgpr_read_b32 v10, a4
    v_accvgpr_read_b32 v11, a5
    v_accvgpr_read_b32 v12, a6
    v_accvgpr_read_b32 v13, a7
    v_mul_f32 v10, v10, v8
    v_mul_f32 v11, v11, v8
    v_mul_f32 v12, v12, v8
    v_mul_f32 v13, v13, v8
    v_cvt_pk_bf16_f32 v14, v10, v11
    v_cvt_pk_bf16_f32 v15, v12, v13
    v_xor_b32 v81, 16, v7
    v_add_u32 v81, v81, v6
    ds_write_b64 v81, v[14:15] offset:0
    v_accvgpr_read_b32 v10, a8
    v_accvgpr_read_b32 v11, a9
    v_accvgpr_read_b32 v12, a10
    v_accvgpr_read_b32 v13, a11
    v_mul_f32 v10, v10, v8
    v_mul_f32 v11, v11, v8
    v_mul_f32 v12, v12, v8
    v_mul_f32 v13, v13, v8
    v_cvt_pk_bf16_f32 v14, v10, v11
    v_cvt_pk_bf16_f32 v15, v12, v13
    v_xor_b32 v82, 32, v7
    v_add_u32 v82, v82, v6
    ds_write_b64 v82, v[14:15] offset:0
    v_accvgpr_read_b32 v10, a12
    v_accvgpr_read_b32 v11, a13
    v_accvgpr_read_b32 v12, a14
    v_accvgpr_read_b32 v13, a15
    v_mul_f32 v10, v10, v8
    v_mul_f32 v11, v11, v8
    v_mul_f32 v12, v12, v8
    v_mul_f32 v13, v13, v8
    v_cvt_pk_bf16_f32 v14, v10, v11
    v_cvt_pk_bf16_f32 v15, v12, v13
    v_xor_b32 v83, 48, v7
    v_add_u32 v83, v83, v6
    ds_write_b64 v83, v[14:15] offset:0
    v_accvgpr_read_b32 v10, a16
    v_accvgpr_read_b32 v11, a17
    v_accvgpr_read_b32 v12, a18
    v_accvgpr_read_b32 v13, a19
    v_mul_f32 v10, v10, v8
    v_mul_f32 v11, v11, v8
    v_mul_f32 v12, v12, v8
    v_mul_f32 v13, v13, v8
    v_cvt_pk_bf16_f32 v14, v10, v11
    v_cvt_pk_bf16_f32 v15, v12, v13
    v_xor_b32 v84, 64, v7
    v_add_u32 v84, v84, v6
    ds_write_b64 v84, v[14:15] offset:0
    v_accvgpr_read_b32 v10, a20
    v_accvgpr_read_b32 v11, a21
    v_accvgpr_read_b32 v12, a22
    v_accvgpr_read_b32 v13, a23
    v_mul_f32 v10, v10, v8
    v_mul_f32 v11, v11, v8
    v_mul_f32 v12, v12, v8
    v_mul_f32 v13, v13, v8
    v_cvt_pk_bf16_f32 v14, v10, v11
    v_cvt_pk_bf16_f32 v15, v12, v13
    v_xor_b32 v85, 80, v7
    v_add_u32 v85, v85, v6
    ds_write_b64 v85, v[14:15] offset:0
    v_accvgpr_read_b32 v10, a24
    v_accvgpr_read_b32 v11, a25
    v_accvgpr_read_b32 v12, a26
    v_accvgpr_read_b32 v13, a27
    v_mul_f32 v10, v10, v8
    v_mul_f32 v11, v11, v8
    v_mul_f32 v12, v12, v8
    v_mul_f32 v13, v13, v8
    v_cvt_pk_bf16_f32 v14, v10, v11
    v_cvt_pk_bf16_f32 v15, v12, v13
    v_xor_b32 v86, 96, v7
    v_add_u32 v86, v86, v6
    ds_write_b64 v86, v[14:15] offset:0
    v_accvgpr_read_b32 v10, a28
    v_accvgpr_read_b32 v11, a29
    v_accvgpr_read_b32 v12, a30
    v_accvgpr_read_b32 v13, a31
    v_mul_f32 v10, v10, v8
    v_mul_f32 v11, v11, v8
    v_mul_f32 v12, v12, v8
    v_mul_f32 v13, v13, v8
    v_cvt_pk_bf16_f32 v14, v10, v11
    v_cvt_pk_bf16_f32 v15, v12, v13
    v_xor_b32 v87, 112, v7
    v_add_u32 v87, v87, v6
    ds_write_b64 v87, v[14:15] offset:0
    v_accvgpr_read_b32 v10, a32
    v_accvgpr_read_b32 v11, a33
    v_accvgpr_read_b32 v12, a34
    v_accvgpr_read_b32 v13, a35
    v_mul_f32 v10, v10, v8
    v_mul_f32 v11, v11, v8
    v_mul_f32 v12, v12, v8
    v_mul_f32 v13, v13, v8
    v_cvt_pk_bf16_f32 v14, v10, v11
    v_cvt_pk_bf16_f32 v15, v12, v13
    v_xor_b32 v80, 128, v7
    v_add_u32 v80, v80, v6
    ds_write_b64 v80, v[14:15] offset:0
    v_accvgpr_read_b32 v10, a36
    v_accvgpr_read_b32 v11, a37
    v_accvgpr_read_b32 v12, a38
    v_accvgpr_read_b32 v13, a39
    v_mul_f32 v10, v10, v8
    v_mul_f32 v11, v11, v8
    v_mul_f32 v12, v12, v8
    v_mul_f32 v13, v13, v8
    v_cvt_pk_bf16_f32 v14, v10, v11
    v_cvt_pk_bf16_f32 v15, v12, v13
    v_xor_b32 v81, 144, v7
    v_add_u32 v81, v81, v6
    ds_write_b64 v81, v[14:15] offset:0
    v_accvgpr_read_b32 v10, a40
    v_accvgpr_read_b32 v11, a41
    v_accvgpr_read_b32 v12, a42
    v_accvgpr_read_b32 v13, a43
    v_mul_f32 v10, v10, v8
    v_mul_f32 v11, v11, v8
    v_mul_f32 v12, v12, v8
    v_mul_f32 v13, v13, v8
    v_cvt_pk_bf16_f32 v14, v10, v11
    v_cvt_pk_bf16_f32 v15, v12, v13
    v_xor_b32 v82, 160, v7
    v_add_u32 v82, v82, v6
    ds_write_b64 v82, v[14:15] offset:0
    v_accvgpr_read_b32 v10, a44
    v_accvgpr_read_b32 v11, a45
    v_accvgpr_read_b32 v12, a46
    v_accvgpr_read_b32 v13, a47
    v_mul_f32 v10, v10, v8
    v_mul_f32 v11, v11, v8
    v_mul_f32 v12, v12, v8
    v_mul_f32 v13, v13, v8
    v_cvt_pk_bf16_f32 v14, v10, v11
    v_cvt_pk_bf16_f32 v15, v12, v13
    v_xor_b32 v83, 176, v7
    v_add_u32 v83, v83, v6
    ds_write_b64 v83, v[14:15] offset:0
    v_accvgpr_read_b32 v10, a48
    v_accvgpr_read_b32 v11, a49
    v_accvgpr_read_b32 v12, a50
    v_accvgpr_read_b32 v13, a51
    v_mul_f32 v10, v10, v8
    v_mul_f32 v11, v11, v8
    v_mul_f32 v12, v12, v8
    v_mul_f32 v13, v13, v8
    v_cvt_pk_bf16_f32 v14, v10, v11
    v_cvt_pk_bf16_f32 v15, v12, v13
    v_xor_b32 v84, 192, v7
    v_add_u32 v84, v84, v6
    ds_write_b64 v84, v[14:15] offset:0
    v_accvgpr_read_b32 v10, a52
    v_accvgpr_read_b32 v11, a53
    v_accvgpr_read_b32 v12, a54
    v_accvgpr_read_b32 v13, a55
    v_mul_f32 v10, v10, v8
    v_mul_f32 v11, v11, v8
    v_mul_f32 v12, v12, v8
    v_mul_f32 v13, v13, v8
    v_cvt_pk_bf16_f32 v14, v10, v11
    v_cvt_pk_bf16_f32 v15, v12, v13
    v_xor_b32 v85, 208, v7
    v_add_u32 v85, v85, v6
    ds_write_b64 v85, v[14:15] offset:0
    v_accvgpr_read_b32 v10, a56
    v_accvgpr_read_b32 v11, a57
    v_accvgpr_read_b32 v12, a58
    v_accvgpr_read_b32 v13, a59
    v_mul_f32 v10, v10, v8
    v_mul_f32 v11, v11, v8
    v_mul_f32 v12, v12, v8
    v_mul_f32 v13, v13, v8
    v_cvt_pk_bf16_f32 v14, v10, v11
    v_cvt_pk_bf16_f32 v15, v12, v13
    v_xor_b32 v86, 224, v7
    v_add_u32 v86, v86, v6
    ds_write_b64 v86, v[14:15] offset:0
    v_accvgpr_read_b32 v10, a60
    v_accvgpr_read_b32 v11, a61
    v_accvgpr_read_b32 v12, a62
    v_accvgpr_read_b32 v13, a63
    v_mul_f32 v10, v10, v8
    v_mul_f32 v11, v11, v8
    v_mul_f32 v12, v12, v8
    v_mul_f32 v13, v13, v8
    v_cvt_pk_bf16_f32 v14, v10, v11
    v_cvt_pk_bf16_f32 v15, v12, v13
    v_xor_b32 v87, 240, v7
    v_add_u32 v87, v87, v6
    s_waitcnt lgkmcnt(14)
    ds_write_b64 v87, v[14:15] offset:0
    v_accvgpr_read_b32 v10, a64
    v_accvgpr_read_b32 v11, a65
    v_accvgpr_read_b32 v12, a66
    v_accvgpr_read_b32 v13, a67
    v_mul_f32 v10, v10, v9
    v_mul_f32 v11, v11, v9
    v_mul_f32 v12, v12, v9
    v_mul_f32 v13, v13, v9
    v_cvt_pk_bf16_f32 v14, v10, v11
    v_cvt_pk_bf16_f32 v15, v12, v13
    v_xor_b32 v80, 0, v7
    v_add_u32 v80, v80, v6
    s_waitcnt lgkmcnt(14)
    ds_write_b64 v80, v[14:15] offset:8192
    v_accvgpr_read_b32 v10, a68
    v_accvgpr_read_b32 v11, a69
    v_accvgpr_read_b32 v12, a70
    v_accvgpr_read_b32 v13, a71
    v_mul_f32 v10, v10, v9
    v_mul_f32 v11, v11, v9
    v_mul_f32 v12, v12, v9
    v_mul_f32 v13, v13, v9
    v_cvt_pk_bf16_f32 v14, v10, v11
    v_cvt_pk_bf16_f32 v15, v12, v13
    v_xor_b32 v81, 16, v7
    v_add_u32 v81, v81, v6
    s_waitcnt lgkmcnt(14)
    ds_write_b64 v81, v[14:15] offset:8192
    v_accvgpr_read_b32 v10, a72
    v_accvgpr_read_b32 v11, a73
    v_accvgpr_read_b32 v12, a74
    v_accvgpr_read_b32 v13, a75
    v_mul_f32 v10, v10, v9
    v_mul_f32 v11, v11, v9
    v_mul_f32 v12, v12, v9
    v_mul_f32 v13, v13, v9
    v_cvt_pk_bf16_f32 v14, v10, v11
    v_cvt_pk_bf16_f32 v15, v12, v13
    v_xor_b32 v82, 32, v7
    v_add_u32 v82, v82, v6
    s_waitcnt lgkmcnt(14)
    ds_write_b64 v82, v[14:15] offset:8192
    v_accvgpr_read_b32 v10, a76
    v_accvgpr_read_b32 v11, a77
    v_accvgpr_read_b32 v12, a78
    v_accvgpr_read_b32 v13, a79
    v_mul_f32 v10, v10, v9
    v_mul_f32 v11, v11, v9
    v_mul_f32 v12, v12, v9
    v_mul_f32 v13, v13, v9
    v_cvt_pk_bf16_f32 v14, v10, v11
    v_cvt_pk_bf16_f32 v15, v12, v13
    v_xor_b32 v83, 48, v7
    v_add_u32 v83, v83, v6
    s_waitcnt lgkmcnt(14)
    ds_write_b64 v83, v[14:15] offset:8192
    v_accvgpr_read_b32 v10, a80
    v_accvgpr_read_b32 v11, a81
    v_accvgpr_read_b32 v12, a82
    v_accvgpr_read_b32 v13, a83
    v_mul_f32 v10, v10, v9
    v_mul_f32 v11, v11, v9
    v_mul_f32 v12, v12, v9
    v_mul_f32 v13, v13, v9
    v_cvt_pk_bf16_f32 v14, v10, v11
    v_cvt_pk_bf16_f32 v15, v12, v13
    v_xor_b32 v84, 64, v7
    v_add_u32 v84, v84, v6
    s_waitcnt lgkmcnt(14)
    ds_write_b64 v84, v[14:15] offset:8192
    v_accvgpr_read_b32 v10, a84
    v_accvgpr_read_b32 v11, a85
    v_accvgpr_read_b32 v12, a86
    v_accvgpr_read_b32 v13, a87
    v_mul_f32 v10, v10, v9
    v_mul_f32 v11, v11, v9
    v_mul_f32 v12, v12, v9
    v_mul_f32 v13, v13, v9
    v_cvt_pk_bf16_f32 v14, v10, v11
    v_cvt_pk_bf16_f32 v15, v12, v13
    v_xor_b32 v85, 80, v7
    v_add_u32 v85, v85, v6
    s_waitcnt lgkmcnt(14)
    ds_write_b64 v85, v[14:15] offset:8192
    v_accvgpr_read_b32 v10, a88
    v_accvgpr_read_b32 v11, a89
    v_accvgpr_read_b32 v12, a90
    v_accvgpr_read_b32 v13, a91
    v_mul_f32 v10, v10, v9
    v_mul_f32 v11, v11, v9
    v_mul_f32 v12, v12, v9
    v_mul_f32 v13, v13, v9
    v_cvt_pk_bf16_f32 v14, v10, v11
    v_cvt_pk_bf16_f32 v15, v12, v13
    v_xor_b32 v86, 96, v7
    v_add_u32 v86, v86, v6
    s_waitcnt lgkmcnt(14)
    ds_write_b64 v86, v[14:15] offset:8192
    v_accvgpr_read_b32 v10, a92
    v_accvgpr_read_b32 v11, a93
    v_accvgpr_read_b32 v12, a94
    v_accvgpr_read_b32 v13, a95
    v_mul_f32 v10, v10, v9
    v_mul_f32 v11, v11, v9
    v_mul_f32 v12, v12, v9
    v_mul_f32 v13, v13, v9
    v_cvt_pk_bf16_f32 v14, v10, v11
    v_cvt_pk_bf16_f32 v15, v12, v13
    v_xor_b32 v87, 112, v7
    v_add_u32 v87, v87, v6
    s_waitcnt lgkmcnt(14)
    ds_write_b64 v87, v[14:15] offset:8192
    v_accvgpr_read_b32 v10, a96
    v_accvgpr_read_b32 v11, a97
    v_accvgpr_read_b32 v12, a98
    v_accvgpr_read_b32 v13, a99
    v_mul_f32 v10, v10, v9
    v_mul_f32 v11, v11, v9
    v_mul_f32 v12, v12, v9
    v_mul_f32 v13, v13, v9
    v_cvt_pk_bf16_f32 v14, v10, v11
    v_cvt_pk_bf16_f32 v15, v12, v13
    v_xor_b32 v80, 128, v7
    v_add_u32 v80, v80, v6
    s_waitcnt lgkmcnt(14)
    ds_write_b64 v80, v[14:15] offset:8192
    v_accvgpr_read_b32 v10, a100
    v_accvgpr_read_b32 v11, a101
    v_accvgpr_read_b32 v12, a102
    v_accvgpr_read_b32 v13, a103
    v_mul_f32 v10, v10, v9
    v_mul_f32 v11, v11, v9
    v_mul_f32 v12, v12, v9
    v_mul_f32 v13, v13, v9
    v_cvt_pk_bf16_f32 v14, v10, v11
    v_cvt_pk_bf16_f32 v15, v12, v13
    v_xor_b32 v81, 144, v7
    v_add_u32 v81, v81, v6
    s_waitcnt lgkmcnt(14)
    ds_write_b64 v81, v[14:15] offset:8192
    v_accvgpr_read_b32 v10, a104
    v_accvgpr_read_b32 v11, a105
    v_accvgpr_read_b32 v12, a106
    v_accvgpr_read_b32 v13, a107
    v_mul_f32 v10, v10, v9
    v_mul_f32 v11, v11, v9
    v_mul_f32 v12, v12, v9
    v_mul_f32 v13, v13, v9
    v_cvt_pk_bf16_f32 v14, v10, v11
    v_cvt_pk_bf16_f32 v15, v12, v13
    v_xor_b32 v82, 160, v7
    v_add_u32 v82, v82, v6
    s_waitcnt lgkmcnt(14)
    ds_write_b64 v82, v[14:15] offset:8192
    v_accvgpr_read_b32 v10, a108
    v_accvgpr_read_b32 v11, a109
    v_accvgpr_read_b32 v12, a110
    v_accvgpr_read_b32 v13, a111
    v_mul_f32 v10, v10, v9
    v_mul_f32 v11, v11, v9
    v_mul_f32 v12, v12, v9
    v_mul_f32 v13, v13, v9
    v_cvt_pk_bf16_f32 v14, v10, v11
    v_cvt_pk_bf16_f32 v15, v12, v13
    v_xor_b32 v83, 176, v7
    v_add_u32 v83, v83, v6
    s_waitcnt lgkmcnt(14)
    ds_write_b64 v83, v[14:15] offset:8192
    v_accvgpr_read_b32 v10, a112
    v_accvgpr_read_b32 v11, a113
    v_accvgpr_read_b32 v12, a114
    v_accvgpr_read_b32 v13, a115
    v_mul_f32 v10, v10, v9
    v_mul_f32 v11, v11, v9
    v_mul_f32 v12, v12, v9
    v_mul_f32 v13, v13, v9
    v_cvt_pk_bf16_f32 v14, v10, v11
    v_cvt_pk_bf16_f32 v15, v12, v13
    v_xor_b32 v84, 192, v7
    v_add_u32 v84, v84, v6
    s_waitcnt lgkmcnt(14)
    ds_write_b64 v84, v[14:15] offset:8192
    v_accvgpr_read_b32 v10, a116
    v_accvgpr_read_b32 v11, a117
    v_accvgpr_read_b32 v12, a118
    v_accvgpr_read_b32 v13, a119
    v_mul_f32 v10, v10, v9
    v_mul_f32 v11, v11, v9
    v_mul_f32 v12, v12, v9
    v_mul_f32 v13, v13, v9
    v_cvt_pk_bf16_f32 v14, v10, v11
    v_cvt_pk_bf16_f32 v15, v12, v13
    v_xor_b32 v85, 208, v7
    v_add_u32 v85, v85, v6
    s_waitcnt lgkmcnt(14)
    ds_write_b64 v85, v[14:15] offset:8192
    v_accvgpr_read_b32 v10, a120
    v_accvgpr_read_b32 v11, a121
    v_accvgpr_read_b32 v12, a122
    v_accvgpr_read_b32 v13, a123
    v_mul_f32 v10, v10, v9
    v_mul_f32 v11, v11, v9
    v_mul_f32 v12, v12, v9
    v_mul_f32 v13, v13, v9
    v_cvt_pk_bf16_f32 v14, v10, v11
    v_cvt_pk_bf16_f32 v15, v12, v13
    v_xor_b32 v86, 224, v7
    v_add_u32 v86, v86, v6
    s_waitcnt lgkmcnt(14)
    ds_write_b64 v86, v[14:15] offset:8192
    v_accvgpr_read_b32 v10, a124
    v_accvgpr_read_b32 v11, a125
    v_accvgpr_read_b32 v12, a126
    v_accvgpr_read_b32 v13, a127
    v_mul_f32 v10, v10, v9
    v_mul_f32 v11, v11, v9
    v_mul_f32 v12, v12, v9
    v_mul_f32 v13, v13, v9
    v_cvt_pk_bf16_f32 v14, v10, v11
    v_cvt_pk_bf16_f32 v15, v12, v13
    v_xor_b32 v87, 240, v7
    v_add_u32 v87, v87, v6
    s_waitcnt lgkmcnt(14)
    ds_write_b64 v87, v[14:15] offset:8192
    s_waitcnt lgkmcnt(0)
    v_lshrrev_b32 v2, 4, v1
    v_lshlrev_b32 v3, 8, v2
    v_add_u32 v3, s46, v3
    v_add_u32 v112, v3, v240
    v_add_u32 v113, v3, v241
    v_add_u32 v114, v3, v242
    v_add_u32 v115, v3, v243
    s_lshl_b32 s46, s48, 2
    s_lshl_b32 s47, s49, 6
    s_lshl_b32 s51, s43, 4
    s_add_u32 s47, s47, s51
    v_add_u32 v239, s46, v2
    v_lshlrev_b32 v239, 11, v239
    v_add_u32 v239, s47, v239
    v_lshlrev_b32 v239, 8, v239
    v_and_b32 v4, 15, v1
    v_lshl_add_u32 v239, v4, 4, v239
    ds_read_b128 v[16:19], v112 offset:0
    ds_read_b128 v[20:23], v113 offset:1024
    ds_read_b128 v[24:27], v114 offset:2048
    ds_read_b128 v[28:31], v115 offset:3072
    ds_read_b128 v[32:35], v112 offset:4096
    ds_read_b128 v[36:39], v113 offset:5120
    ds_read_b128 v[40:43], v114 offset:6144
    ds_read_b128 v[44:47], v115 offset:7168
    ds_read_b128 v[48:51], v112 offset:8192
    ds_read_b128 v[52:55], v113 offset:9216
    ds_read_b128 v[56:59], v114 offset:10240
    ds_read_b128 v[60:63], v115 offset:11264
    ds_read_b128 v[64:67], v112 offset:12288
    ds_read_b128 v[68:71], v113 offset:13312
    ds_read_b128 v[72:75], v114 offset:14336
    s_waitcnt lgkmcnt(14)
    ds_read_b128 v[76:79], v115 offset:15360
    buffer_store_dwordx4 v[16:19], v239, s[28:31], 0 offen offset:0
    s_waitcnt lgkmcnt(14)
    buffer_store_dwordx4 v[20:23], v239, s[28:31], 0 offen offset:256
    s_waitcnt lgkmcnt(13)
    buffer_store_dwordx4 v[24:27], v239, s[28:31], 0 offen offset:512
    s_waitcnt lgkmcnt(12)
    buffer_store_dwordx4 v[28:31], v239, s[28:31], 0 offen offset:768
    s_waitcnt lgkmcnt(11)
    buffer_store_dwordx4 v[32:35], v239, s[28:31], 0 offen offset:1024
    s_waitcnt lgkmcnt(10)
    buffer_store_dwordx4 v[36:39], v239, s[28:31], 0 offen offset:1280
    s_waitcnt lgkmcnt(9)
    buffer_store_dwordx4 v[40:43], v239, s[28:31], 0 offen offset:1536
    s_waitcnt lgkmcnt(8)
    buffer_store_dwordx4 v[44:47], v239, s[28:31], 0 offen offset:1792
    s_waitcnt lgkmcnt(7)
    buffer_store_dwordx4 v[48:51], v239, s[28:31], 0 offen offset:2048
    s_waitcnt lgkmcnt(6)
    buffer_store_dwordx4 v[52:55], v239, s[28:31], 0 offen offset:2304
    s_waitcnt lgkmcnt(5)
    buffer_store_dwordx4 v[56:59], v239, s[28:31], 0 offen offset:2560
    s_waitcnt lgkmcnt(4)
    buffer_store_dwordx4 v[60:63], v239, s[28:31], 0 offen offset:2816
    s_waitcnt lgkmcnt(3)
    buffer_store_dwordx4 v[64:67], v239, s[28:31], 0 offen offset:3072
    s_waitcnt lgkmcnt(2)
    buffer_store_dwordx4 v[68:71], v239, s[28:31], 0 offen offset:3328
    s_waitcnt lgkmcnt(1)
    buffer_store_dwordx4 v[72:75], v239, s[28:31], 0 offen offset:3584
    s_waitcnt lgkmcnt(0)
    buffer_store_dwordx4 v[76:79], v239, s[28:31], 0 offen offset:3840
    s_waitcnt vmcnt(0)
L_end:
    s_endpgm
L_rare00:
    s_nop 4
    v_mov_b32 v172, v171
    s_nop 1
    v_permlane32_swap_b32 v171, v172
    s_nop 1
    v_max_f32 v171, v171, v172
    v_max_f32 v171, 0, v171
    v_sub_f32 v16, v16, v171
    v_sub_f32 v17, v17, v171
    v_sub_f32 v18, v18, v171
    v_sub_f32 v19, v19, v171
    v_sub_f32 v20, v20, v171
    v_sub_f32 v21, v21, v171
    v_sub_f32 v22, v22, v171
    v_sub_f32 v23, v23, v171
    v_sub_f32 v24, v24, v171
    v_sub_f32 v25, v25, v171
    v_sub_f32 v26, v26, v171
    v_sub_f32 v27, v27, v171
    v_sub_f32 v28, v28, v171
    v_sub_f32 v29, v29, v171
    v_sub_f32 v30, v30, v171
    v_sub_f32 v31, v31, v171
    v_sub_f32 v192, v192, v171
    v_sub_f32 v193, v193, v171
    v_sub_f32 v194, v194, v171
    v_sub_f32 v195, v195, v171
    v_sub_f32 v196, v196, v171
    v_sub_f32 v197, v197, v171
    v_sub_f32 v198, v198, v171
    v_sub_f32 v199, v199, v171
    v_sub_f32 v200, v200, v171
    v_sub_f32 v201, v201, v171
    v_sub_f32 v202, v202, v171
    v_sub_f32 v203, v203, v171
    v_sub_f32 v204, v204, v171
    v_sub_f32 v205, v205, v171
    v_sub_f32 v206, v206, v171
    v_sub_f32 v207, v207, v171
    v_exp_f32_e64 v172, -v171
    s_nop 1
    v_mul_f32 v168, v168, v172
    v_mul_f32 v169, v169, v172
    v_mul_f32 v170, v170, v172
    s_mov_b32 s39, 1
    s_nop 4
    s_setpc_b64 s[40:41]
L_rare01:
    s_nop 4
    v_mov_b32 v172, v171
    s_nop 1
    v_permlane32_swap_b32 v171, v172
    s_nop 1
    v_max_f32 v171, v171, v172
    v_max_f32 v171, 0, v171
    v_sub_f32 v48, v48, v171
    v_sub_f32 v49, v49, v171
    v_sub_f32 v50, v50, v171
    v_sub_f32 v51, v51, v171
    v_sub_f32 v52, v52, v171
    v_sub_f32 v53, v53, v171
    v_sub_f32 v54, v54, v171
    v_sub_f32 v55, v55, v171
    v_sub_f32 v56, v56, v171
    v_sub_f32 v57, v57, v171
    v_sub_f32 v58, v58, v171
    v_sub_f32 v59, v59, v171
    v_sub_f32 v60, v60, v171
    v_sub_f32 v61, v61, v171
    v_sub_f32 v62, v62, v171
    v_sub_f32 v63, v63, v171
    v_sub_f32 v192, v192, v171
    v_sub_f32 v193, v193, v171
    v_sub_f32 v194, v194, v171
    v_sub_f32 v195, v195, v171
    v_sub_f32 v196, v196, v171
    v_sub_f32 v197, v197, v171
    v_sub_f32 v198, v198, v171
    v_sub_f32 v199, v199, v171
    v_sub_f32 v200, v200, v171
    v_sub_f32 v201, v201, v171
    v_sub_f32 v202, v202, v171
    v_sub_f32 v203, v203, v171
    v_sub_f32 v204, v204, v171
    v_sub_f32 v205, v205, v171
    v_sub_f32 v206, v206, v171
    v_sub_f32 v207, v207, v171
    v_exp_f32_e64 v172, -v171
    s_nop 1
    v_mul_f32 v168, v168, v172
    v_mul_f32 v169, v169, v172
    v_mul_f32 v170, v170, v172
    s_mov_b32 s39, 1
    s_nop 4
    s_setpc_b64 s[40:41]
L_rare10:
    s_nop 4
    v_mov_b32 v177, v176
    s_nop 1
    v_permlane32_swap_b32 v176, v177
    s_nop 1
    v_max_f32 v176, v176, v177
    v_max_f32 v176, 0, v176
    v_sub_f32 v32, v32, v176
    v_sub_f32 v33, v33, v176
    v_sub_f32 v34, v34, v176
    v_sub_f32 v35, v35, v176
    v_sub_f32 v36, v36, v176
    v_sub_f32 v37, v37, v176
    v_sub_f32 v38, v38, v176
    v_sub_f32 v39, v39, v176
    v_sub_f32 v40, v40, v176
    v_sub_f32 v41, v41, v176
    v_sub_f32 v42, v42, v176
    v_sub_f32 v43, v43, v176
    v_sub_f32 v44, v44, v176
    v_sub_f32 v45, v45, v176
    v_sub_f32 v46, v46, v176
    v_sub_f32 v47, v47, v176
    v_sub_f32 v208, v208, v176
    v_sub_f32 v209, v209, v176
    v_sub_f32 v210, v210, v176
    v_sub_f32 v211, v211, v176
    v_sub_f32 v212, v212, v176
    v_sub_f32 v213, v213, v176
    v_sub_f32 v214, v214, v176
    v_sub_f32 v215, v215, v176
    v_sub_f32 v216, v216, v176
    v_sub_f32 v217, v217, v176
    v_sub_f32 v218, v218, v176
    v_sub_f32 v219, v219, v176
    v_sub_f32 v220, v220, v176
    v_sub_f32 v221, v221, v176
    v_sub_f32 v222, v222, v176
    v_sub_f32 v223, v223, v176
    v_exp_f32_e64 v177, -v176
    s_nop 1
    v_mul_f32 v173, v173, v177
    v_mul_f32 v174, v174, v177
    v_mul_f32 v175, v175, v177
    s_mov_b32 s39, 1
    s_nop 4
    s_setpc_b64 s[40:41]
L_rare11:
    s_nop 4
    v_mov_b32 v177, v176
    s_nop 1
    v_permlane32_swap_b32 v176, v177
    s_nop 1
    v_max_f32 v176, v176, v177
    v_max_f32 v176, 0, v176
    v_sub_f32 v64, v64, v176
    v_sub_f32 v65, v65, v176
    v_sub_f32 v66, v66, v176
    v_sub_f32 v67, v67, v176
    v_sub_f32 v68, v68, v176
    v_sub_f32 v69, v69, v176
    v_sub_f32 v70, v70, v176
    v_sub_f32 v71, v71, v176
    v_sub_f32 v72, v72, v176
    v_sub_f32 v73, v73, v176
    v_sub_f32 v74, v74, v176
    v_sub_f32 v75, v75, v176
    v_sub_f32 v76, v76, v176
    v_sub_f32 v77, v77, v176
    v_sub_f32 v78, v78, v176
    v_sub_f32 v79, v79, v176
    v_sub_f32 v208, v208, v176
    v_sub_f32 v209, v209, v176
    v_sub_f32 v210, v210, v176
    v_sub_f32 v211, v211, v176
    v_sub_f32 v212, v212, v176
    v_sub_f32 v213, v213, v176
    v_sub_f32 v214, v214, v176
    v_sub_f32 v215, v215, v176
    v_sub_f32 v216, v216, v176
    v_sub_f32 v217, v217, v176
    v_sub_f32 v218, v218, v176
    v_sub_f32 v219, v219, v176
    v_sub_f32 v220, v220, v176
    v_sub_f32 v221, v221, v176
    v_sub_f32 v222, v222, v176
    v_sub_f32 v223, v223, v176
    v_exp_f32_e64 v177, -v176
    s_nop 1
    v_mul_f32 v173, v173, v177
    v_mul_f32 v174, v174, v177
    v_mul_f32 v175, v175, v177
    s_mov_b32 s39, 1
    s_nop 4
    s_setpc_b64 s[40:41]
L_apply:
    s_nop 15
    v_accvgpr_read_b32 v10, a0
    s_nop 0
    v_mul_f32 v10, v10, v170
    s_nop 0
    v_accvgpr_write_b32 a0, v10
    v_accvgpr_read_b32 v11, a1
    s_nop 0
    v_mul_f32 v11, v11, v170
    s_nop 0
    v_accvgpr_write_b32 a1, v11
    v_accvgpr_read_b32 v12, a2
    s_nop 0
    v_mul_f32 v12, v12, v170
    s_nop 0
    v_accvgpr_write_b32 a2, v12
    v_accvgpr_read_b32 v13, a3
    s_nop 0
    v_mul_f32 v13, v13, v170
    s_nop 0
    v_accvgpr_write_b32 a3, v13
    v_accvgpr_read_b32 v10, a4
    s_nop 0
    v_mul_f32 v10, v10, v170
    s_nop 0
    v_accvgpr_write_b32 a4, v10
    v_accvgpr_read_b32 v11, a5
    s_nop 0
    v_mul_f32 v11, v11, v170
    s_nop 0
    v_accvgpr_write_b32 a5, v11
    v_accvgpr_read_b32 v12, a6
    s_nop 0
    v_mul_f32 v12, v12, v170
    s_nop 0
    v_accvgpr_write_b32 a6, v12
    v_accvgpr_read_b32 v13, a7
    s_nop 0
    v_mul_f32 v13, v13, v170
    s_nop 0
    v_accvgpr_write_b32 a7, v13
    v_accvgpr_read_b32 v10, a8
    s_nop 0
    v_mul_f32 v10, v10, v170
    s_nop 0
    v_accvgpr_write_b32 a8, v10
    v_accvgpr_read_b32 v11, a9
    s_nop 0
    v_mul_f32 v11, v11, v170
    s_nop 0
    v_accvgpr_write_b32 a9, v11
    v_accvgpr_read_b32 v12, a10
    s_nop 0
    v_mul_f32 v12, v12, v170
    s_nop 0
    v_accvgpr_write_b32 a10, v12
    v_accvgpr_read_b32 v13, a11
    s_nop 0
    v_mul_f32 v13, v13, v170
    s_nop 0
    v_accvgpr_write_b32 a11, v13
    v_accvgpr_read_b32 v10, a12
    s_nop 0
    v_mul_f32 v10, v10, v170
    s_nop 0
    v_accvgpr_write_b32 a12, v10
    v_accvgpr_read_b32 v11, a13
    s_nop 0
    v_mul_f32 v11, v11, v170
    s_nop 0
    v_accvgpr_write_b32 a13, v11
    v_accvgpr_read_b32 v12, a14
    s_nop 0
    v_mul_f32 v12, v12, v170
    s_nop 0
    v_accvgpr_write_b32 a14, v12
    v_accvgpr_read_b32 v13, a15
    s_nop 0
    v_mul_f32 v13, v13, v170
    s_nop 0
    v_accvgpr_write_b32 a15, v13
    v_accvgpr_read_b32 v10, a16
    s_nop 0
    v_mul_f32 v10, v10, v170
    s_nop 0
    v_accvgpr_write_b32 a16, v10
    v_accvgpr_read_b32 v11, a17
    s_nop 0
    v_mul_f32 v11, v11, v170
    s_nop 0
    v_accvgpr_write_b32 a17, v11
    v_accvgpr_read_b32 v12, a18
    s_nop 0
    v_mul_f32 v12, v12, v170
    s_nop 0
    v_accvgpr_write_b32 a18, v12
    v_accvgpr_read_b32 v13, a19
    s_nop 0
    v_mul_f32 v13, v13, v170
    s_nop 0
    v_accvgpr_write_b32 a19, v13
    v_accvgpr_read_b32 v10, a20
    s_nop 0
    v_mul_f32 v10, v10, v170
    s_nop 0
    v_accvgpr_write_b32 a20, v10
    v_accvgpr_read_b32 v11, a21
    s_nop 0
    v_mul_f32 v11, v11, v170
    s_nop 0
    v_accvgpr_write_b32 a21, v11
    v_accvgpr_read_b32 v12, a22
    s_nop 0
    v_mul_f32 v12, v12, v170
    s_nop 0
    v_accvgpr_write_b32 a22, v12
    v_accvgpr_read_b32 v13, a23
    s_nop 0
    v_mul_f32 v13, v13, v170
    s_nop 0
    v_accvgpr_write_b32 a23, v13
    v_accvgpr_read_b32 v10, a24
    s_nop 0
    v_mul_f32 v10, v10, v170
    s_nop 0
    v_accvgpr_write_b32 a24, v10
    v_accvgpr_read_b32 v11, a25
    s_nop 0
    v_mul_f32 v11, v11, v170
    s_nop 0
    v_accvgpr_write_b32 a25, v11
    v_accvgpr_read_b32 v12, a26
    s_nop 0
    v_mul_f32 v12, v12, v170
    s_nop 0
    v_accvgpr_write_b32 a26, v12
    v_accvgpr_read_b32 v13, a27
    s_nop 0
    v_mul_f32 v13, v13, v170
    s_nop 0
    v_accvgpr_write_b32 a27, v13
    v_accvgpr_read_b32 v10, a28
    s_nop 0
    v_mul_f32 v10, v10, v170
    s_nop 0
    v_accvgpr_write_b32 a28, v10
    v_accvgpr_read_b32 v11, a29
    s_nop 0
    v_mul_f32 v11, v11, v170
    s_nop 0
    v_accvgpr_write_b32 a29, v11
    v_accvgpr_read_b32 v12, a30
    s_nop 0
    v_mul_f32 v12, v12, v170
    s_nop 0
    v_accvgpr_write_b32 a30, v12
    v_accvgpr_read_b32 v13, a31
    s_nop 0
    v_mul_f32 v13, v13, v170
    s_nop 0
    v_accvgpr_write_b32 a31, v13
    v_accvgpr_read_b32 v10, a32
    s_nop 0
    v_mul_f32 v10, v10, v170
    s_nop 0
    v_accvgpr_write_b32 a32, v10
    v_accvgpr_read_b32 v11, a33
    s_nop 0
    v_mul_f32 v11, v11, v170
    s_nop 0
    v_accvgpr_write_b32 a33, v11
    v_accvgpr_read_b32 v12, a34
    s_nop 0
    v_mul_f32 v12, v12, v170
    s_nop 0
    v_accvgpr_write_b32 a34, v12
    v_accvgpr_read_b32 v13, a35
    s_nop 0
    v_mul_f32 v13, v13, v170
    s_nop 0
    v_accvgpr_write_b32 a35, v13
    v_accvgpr_read_b32 v10, a36
    s_nop 0
    v_mul_f32 v10, v10, v170
    s_nop 0
    v_accvgpr_write_b32 a36, v10
    v_accvgpr_read_b32 v11, a37
    s_nop 0
    v_mul_f32 v11, v11, v170
    s_nop 0
    v_accvgpr_write_b32 a37, v11
    v_accvgpr_read_b32 v12, a38
    s_nop 0
    v_mul_f32 v12, v12, v170
    s_nop 0
    v_accvgpr_write_b32 a38, v12
    v_accvgpr_read_b32 v13, a39
    s_nop 0
    v_mul_f32 v13, v13, v170
    s_nop 0
    v_accvgpr_write_b32 a39, v13
    v_accvgpr_read_b32 v10, a40
    s_nop 0
    v_mul_f32 v10, v10, v170
    s_nop 0
    v_accvgpr_write_b32 a40, v10
    v_accvgpr_read_b32 v11, a41
    s_nop 0
    v_mul_f32 v11, v11, v170
    s_nop 0
    v_accvgpr_write_b32 a41, v11
    v_accvgpr_read_b32 v12, a42
    s_nop 0
    v_mul_f32 v12, v12, v170
    s_nop 0
    v_accvgpr_write_b32 a42, v12
    v_accvgpr_read_b32 v13, a43
    s_nop 0
    v_mul_f32 v13, v13, v170
    s_nop 0
    v_accvgpr_write_b32 a43, v13
    v_accvgpr_read_b32 v10, a44
    s_nop 0
    v_mul_f32 v10, v10, v170
    s_nop 0
    v_accvgpr_write_b32 a44, v10
    v_accvgpr_read_b32 v11, a45
    s_nop 0
    v_mul_f32 v11, v11, v170
    s_nop 0
    v_accvgpr_write_b32 a45, v11
    v_accvgpr_read_b32 v12, a46
    s_nop 0
    v_mul_f32 v12, v12, v170
    s_nop 0
    v_accvgpr_write_b32 a46, v12
    v_accvgpr_read_b32 v13, a47
    s_nop 0
    v_mul_f32 v13, v13, v170
    s_nop 0
    v_accvgpr_write_b32 a47, v13
    v_accvgpr_read_b32 v10, a48
    s_nop 0
    v_mul_f32 v10, v10, v170
    s_nop 0
    v_accvgpr_write_b32 a48, v10
    v_accvgpr_read_b32 v11, a49
    s_nop 0
    v_mul_f32 v11, v11, v170
    s_nop 0
    v_accvgpr_write_b32 a49, v11
    v_accvgpr_read_b32 v12, a50
    s_nop 0
    v_mul_f32 v12, v12, v170
    s_nop 0
    v_accvgpr_write_b32 a50, v12
    v_accvgpr_read_b32 v13, a51
    s_nop 0
    v_mul_f32 v13, v13, v170
    s_nop 0
    v_accvgpr_write_b32 a51, v13
    v_accvgpr_read_b32 v10, a52
    s_nop 0
    v_mul_f32 v10, v10, v170
    s_nop 0
    v_accvgpr_write_b32 a52, v10
    v_accvgpr_read_b32 v11, a53
    s_nop 0
    v_mul_f32 v11, v11, v170
    s_nop 0
    v_accvgpr_write_b32 a53, v11
    v_accvgpr_read_b32 v12, a54
    s_nop 0
    v_mul_f32 v12, v12, v170
    s_nop 0
    v_accvgpr_write_b32 a54, v12
    v_accvgpr_read_b32 v13, a55
    s_nop 0
    v_mul_f32 v13, v13, v170
    s_nop 0
    v_accvgpr_write_b32 a55, v13
    v_accvgpr_read_b32 v10, a56
    s_nop 0
    v_mul_f32 v10, v10, v170
    s_nop 0
    v_accvgpr_write_b32 a56, v10
    v_accvgpr_read_b32 v11, a57
    s_nop 0
    v_mul_f32 v11, v11, v170
    s_nop 0
    v_accvgpr_write_b32 a57, v11
    v_accvgpr_read_b32 v12, a58
    s_nop 0
    v_mul_f32 v12, v12, v170
    s_nop 0
    v_accvgpr_write_b32 a58, v12
    v_accvgpr_read_b32 v13, a59
    s_nop 0
    v_mul_f32 v13, v13, v170
    s_nop 0
    v_accvgpr_write_b32 a59, v13
    v_accvgpr_read_b32 v10, a60
    s_nop 0
    v_mul_f32 v10, v10, v170
    s_nop 0
    v_accvgpr_write_b32 a60, v10
    v_accvgpr_read_b32 v11, a61
    s_nop 0
    v_mul_f32 v11, v11, v170
    s_nop 0
    v_accvgpr_write_b32 a61, v11
    v_accvgpr_read_b32 v12, a62
    s_nop 0
    v_mul_f32 v12, v12, v170
    s_nop 0
    v_accvgpr_write_b32 a62, v12
    v_accvgpr_read_b32 v13, a63
    s_nop 0
    v_mul_f32 v13, v13, v170
    s_nop 0
    v_accvgpr_write_b32 a63, v13
    v_mov_b32 v170, 1.0
    v_accvgpr_read_b32 v10, a64
    s_nop 0
    v_mul_f32 v10, v10, v175
    s_nop 0
    v_accvgpr_write_b32 a64, v10
    v_accvgpr_read_b32 v11, a65
    s_nop 0
    v_mul_f32 v11, v11, v175
    s_nop 0
    v_accvgpr_write_b32 a65, v11
    v_accvgpr_read_b32 v12, a66
    s_nop 0
    v_mul_f32 v12, v12, v175
    s_nop 0
    v_accvgpr_write_b32 a66, v12
    v_accvgpr_read_b32 v13, a67
    s_nop 0
    v_mul_f32 v13, v13, v175
    s_nop 0
    v_accvgpr_write_b32 a67, v13
    v_accvgpr_read_b32 v10, a68
    s_nop 0
    v_mul_f32 v10, v10, v175
    s_nop 0
    v_accvgpr_write_b32 a68, v10
    v_accvgpr_read_b32 v11, a69
    s_nop 0
    v_mul_f32 v11, v11, v175
    s_nop 0
    v_accvgpr_write_b32 a69, v11
    v_accvgpr_read_b32 v12, a70
    s_nop 0
    v_mul_f32 v12, v12, v175
    s_nop 0
    v_accvgpr_write_b32 a70, v12
    v_accvgpr_read_b32 v13, a71
    s_nop 0
    v_mul_f32 v13, v13, v175
    s_nop 0
    v_accvgpr_write_b32 a71, v13
    v_accvgpr_read_b32 v10, a72
    s_nop 0
    v_mul_f32 v10, v10, v175
    s_nop 0
    v_accvgpr_write_b32 a72, v10
    v_accvgpr_read_b32 v11, a73
    s_nop 0
    v_mul_f32 v11, v11, v175
    s_nop 0
    v_accvgpr_write_b32 a73, v11
    v_accvgpr_read_b32 v12, a74
    s_nop 0
    v_mul_f32 v12, v12, v175
    s_nop 0
    v_accvgpr_write_b32 a74, v12
    v_accvgpr_read_b32 v13, a75
    s_nop 0
    v_mul_f32 v13, v13, v175
    s_nop 0
    v_accvgpr_write_b32 a75, v13
    v_accvgpr_read_b32 v10, a76
    s_nop 0
    v_mul_f32 v10, v10, v175
    s_nop 0
    v_accvgpr_write_b32 a76, v10
    v_accvgpr_read_b32 v11, a77
    s_nop 0
    v_mul_f32 v11, v11, v175
    s_nop 0
    v_accvgpr_write_b32 a77, v11
    v_accvgpr_read_b32 v12, a78
    s_nop 0
    v_mul_f32 v12, v12, v175
    s_nop 0
    v_accvgpr_write_b32 a78, v12
    v_accvgpr_read_b32 v13, a79
    s_nop 0
    v_mul_f32 v13, v13, v175
    s_nop 0
    v_accvgpr_write_b32 a79, v13
    v_accvgpr_read_b32 v10, a80
    s_nop 0
    v_mul_f32 v10, v10, v175
    s_nop 0
    v_accvgpr_write_b32 a80, v10
    v_accvgpr_read_b32 v11, a81
    s_nop 0
    v_mul_f32 v11, v11, v175
    s_nop 0
    v_accvgpr_write_b32 a81, v11
    v_accvgpr_read_b32 v12, a82
    s_nop 0
    v_mul_f32 v12, v12, v175
    s_nop 0
    v_accvgpr_write_b32 a82, v12
    v_accvgpr_read_b32 v13, a83
    s_nop 0
    v_mul_f32 v13, v13, v175
    s_nop 0
    v_accvgpr_write_b32 a83, v13
    v_accvgpr_read_b32 v10, a84
    s_nop 0
    v_mul_f32 v10, v10, v175
    s_nop 0
    v_accvgpr_write_b32 a84, v10
    v_accvgpr_read_b32 v11, a85
    s_nop 0
    v_mul_f32 v11, v11, v175
    s_nop 0
    v_accvgpr_write_b32 a85, v11
    v_accvgpr_read_b32 v12, a86
    s_nop 0
    v_mul_f32 v12, v12, v175
    s_nop 0
    v_accvgpr_write_b32 a86, v12
    v_accvgpr_read_b32 v13, a87
    s_nop 0
    v_mul_f32 v13, v13, v175
    s_nop 0
    v_accvgpr_write_b32 a87, v13
    v_accvgpr_read_b32 v10, a88
    s_nop 0
    v_mul_f32 v10, v10, v175
    s_nop 0
    v_accvgpr_write_b32 a88, v10
    v_accvgpr_read_b32 v11, a89
    s_nop 0
    v_mul_f32 v11, v11, v175
    s_nop 0
    v_accvgpr_write_b32 a89, v11
    v_accvgpr_read_b32 v12, a90
    s_nop 0
    v_mul_f32 v12, v12, v175
    s_nop 0
    v_accvgpr_write_b32 a90, v12
    v_accvgpr_read_b32 v13, a91
    s_nop 0
    v_mul_f32 v13, v13, v175
    s_nop 0
    v_accvgpr_write_b32 a91, v13
    v_accvgpr_read_b32 v10, a92
    s_nop 0
    v_mul_f32 v10, v10, v175
    s_nop 0
    v_accvgpr_write_b32 a92, v10
    v_accvgpr_read_b32 v11, a93
    s_nop 0
    v_mul_f32 v11, v11, v175
    s_nop 0
    v_accvgpr_write_b32 a93, v11
    v_accvgpr_read_b32 v12, a94
    s_nop 0
    v_mul_f32 v12, v12, v175
    s_nop 0
    v_accvgpr_write_b32 a94, v12
    v_accvgpr_read_b32 v13, a95
    s_nop 0
    v_mul_f32 v13, v13, v175
    s_nop 0
    v_accvgpr_write_b32 a95, v13
    v_accvgpr_read_b32 v10, a96
    s_nop 0
    v_mul_f32 v10, v10, v175
    s_nop 0
    v_accvgpr_write_b32 a96, v10
    v_accvgpr_read_b32 v11, a97
    s_nop 0
    v_mul_f32 v11, v11, v175
    s_nop 0
    v_accvgpr_write_b32 a97, v11
    v_accvgpr_read_b32 v12, a98
    s_nop 0
    v_mul_f32 v12, v12, v175
    s_nop 0
    v_accvgpr_write_b32 a98, v12
    v_accvgpr_read_b32 v13, a99
    s_nop 0
    v_mul_f32 v13, v13, v175
    s_nop 0
    v_accvgpr_write_b32 a99, v13
    v_accvgpr_read_b32 v10, a100
    s_nop 0
    v_mul_f32 v10, v10, v175
    s_nop 0
    v_accvgpr_write_b32 a100, v10
    v_accvgpr_read_b32 v11, a101
    s_nop 0
    v_mul_f32 v11, v11, v175
    s_nop 0
    v_accvgpr_write_b32 a101, v11
    v_accvgpr_read_b32 v12, a102
    s_nop 0
    v_mul_f32 v12, v12, v175
    s_nop 0
    v_accvgpr_write_b32 a102, v12
    v_accvgpr_read_b32 v13, a103
    s_nop 0
    v_mul_f32 v13, v13, v175
    s_nop 0
    v_accvgpr_write_b32 a103, v13
    v_accvgpr_read_b32 v10, a104
    s_nop 0
    v_mul_f32 v10, v10, v175
    s_nop 0
    v_accvgpr_write_b32 a104, v10
    v_accvgpr_read_b32 v11, a105
    s_nop 0
    v_mul_f32 v11, v11, v175
    s_nop 0
    v_accvgpr_write_b32 a105, v11
    v_accvgpr_read_b32 v12, a106
    s_nop 0
    v_mul_f32 v12, v12, v175
    s_nop 0
    v_accvgpr_write_b32 a106, v12
    v_accvgpr_read_b32 v13, a107
    s_nop 0
    v_mul_f32 v13, v13, v175
    s_nop 0
    v_accvgpr_write_b32 a107, v13
    v_accvgpr_read_b32 v10, a108
    s_nop 0
    v_mul_f32 v10, v10, v175
    s_nop 0
    v_accvgpr_write_b32 a108, v10
    v_accvgpr_read_b32 v11, a109
    s_nop 0
    v_mul_f32 v11, v11, v175
    s_nop 0
    v_accvgpr_write_b32 a109, v11
    v_accvgpr_read_b32 v12, a110
    s_nop 0
    v_mul_f32 v12, v12, v175
    s_nop 0
    v_accvgpr_write_b32 a110, v12
    v_accvgpr_read_b32 v13, a111
    s_nop 0
    v_mul_f32 v13, v13, v175
    s_nop 0
    v_accvgpr_write_b32 a111, v13
    v_accvgpr_read_b32 v10, a112
    s_nop 0
    v_mul_f32 v10, v10, v175
    s_nop 0
    v_accvgpr_write_b32 a112, v10
    v_accvgpr_read_b32 v11, a113
    s_nop 0
    v_mul_f32 v11, v11, v175
    s_nop 0
    v_accvgpr_write_b32 a113, v11
    v_accvgpr_read_b32 v12, a114
    s_nop 0
    v_mul_f32 v12, v12, v175
    s_nop 0
    v_accvgpr_write_b32 a114, v12
    v_accvgpr_read_b32 v13, a115
    s_nop 0
    v_mul_f32 v13, v13, v175
    s_nop 0
    v_accvgpr_write_b32 a115, v13
    v_accvgpr_read_b32 v10, a116
    s_nop 0
    v_mul_f32 v10, v10, v175
    s_nop 0
    v_accvgpr_write_b32 a116, v10
    v_accvgpr_read_b32 v11, a117
    s_nop 0
    v_mul_f32 v11, v11, v175
    s_nop 0
    v_accvgpr_write_b32 a117, v11
    v_accvgpr_read_b32 v12, a118
    s_nop 0
    v_mul_f32 v12, v12, v175
    s_nop 0
    v_accvgpr_write_b32 a118, v12
    v_accvgpr_read_b32 v13, a119
    s_nop 0
    v_mul_f32 v13, v13, v175
    s_nop 0
    v_accvgpr_write_b32 a119, v13
    v_accvgpr_read_b32 v10, a120
    s_nop 0
    v_mul_f32 v10, v10, v175
    s_nop 0
    v_accvgpr_write_b32 a120, v10
    v_accvgpr_read_b32 v11, a121
    s_nop 0
    v_mul_f32 v11, v11, v175
    s_nop 0
    v_accvgpr_write_b32 a121, v11
    v_accvgpr_read_b32 v12, a122
    s_nop 0
    v_mul_f32 v12, v12, v175
    s_nop 0
    v_accvgpr_write_b32 a122, v12
    v_accvgpr_read_b32 v13, a123
    s_nop 0
    v_mul_f32 v13, v13, v175
    s_nop 0
    v_accvgpr_write_b32 a123, v13
    v_accvgpr_read_b32 v10, a124
    s_nop 0
    v_mul_f32 v10, v10, v175
    s_nop 0
    v_accvgpr_write_b32 a124, v10
    v_accvgpr_read_b32 v11, a125
    s_nop 0
    v_mul_f32 v11, v11, v175
    s_nop 0
    v_accvgpr_write_b32 a125, v11
    v_accvgpr_read_b32 v12, a126
    s_nop 0
    v_mul_f32 v12, v12, v175
    s_nop 0
    v_accvgpr_write_b32 a126, v12
    v_accvgpr_read_b32 v13, a127
    s_nop 0
    v_mul_f32 v13, v13, v175
    s_nop 0
    v_accvgpr_write_b32 a127, v13
    v_mov_b32 v175, 1.0
    s_mov_b32 s39, 0
    s_nop 4
    s_setpc_b64 s[40:41]
    s_endpgm
.section .rodata,"a"
.p2align 6
.amdhsa_kernel prep_kernel
  .amdhsa_next_free_vgpr 96
  .amdhsa_next_free_sgpr 64
  .amdhsa_accum_offset 96
  .amdhsa_group_segment_fixed_size 0
  .amdhsa_kernarg_size 72
  .amdhsa_user_sgpr_count 2
  .amdhsa_user_sgpr_kernarg_segment_ptr 1
  .amdhsa_system_sgpr_workgroup_id_x 1
.end_amdhsa_kernel
.p2align 6
.amdhsa_kernel standalone__tree_speculative_verify_tree_attention_over_candidate_token_tree__prompt_kernel
  .amdhsa_next_free_vgpr 448
  .amdhsa_next_free_sgpr 96
  .amdhsa_accum_offset 256
  .amdhsa_group_segment_fixed_size 0
  .amdhsa_kernarg_size 72
  .amdhsa_user_sgpr_count 2
  .amdhsa_user_sgpr_kernarg_segment_ptr 1
  .amdhsa_system_sgpr_workgroup_id_x 1
.end_amdhsa_kernel
```
